```python
import torch

def _softmax(x, axis=-1):
    return torch.softmax(x, dim=axis)
def _gelu(x):
    return torch.nn.functional.gelu(x, approximate="tanh")
def _silu(x):
    return torch.nn.functional.silu(x)
def _sigmoid(x):
    return torch.sigmoid(x)
def _layernorm(x, axis=-1, eps=1e-5):
    m = x.mean(dim=axis, keepdim=True)
    v = x.var(dim=axis, keepdim=True, unbiased=False)
    return (x - m) / torch.sqrt(v + eps)
def _scatter_add(tgt, idx, src, axis=0):
    return tgt.clone().index_add_(axis, idx, src)
def _segment_sum(src, seg, n):
    out = torch.zeros((n,) + src.shape[1:], dtype=src.dtype)
    return out.index_add_(0, seg, src)
def _pad(x, pw):
    flat = tuple(v for pair in reversed(pw) for v in pair)
    return torch.nn.functional.pad(x, flat)

kernel_name = 'recurrent_scan__sliding_block_cached__glu_gated_reglu__decode'

def setup_inputs():

    _w = (lambda a: (lambda t: t.to(torch.bfloat16) if t.is_floating_point() else t)(torch.as_tensor(a)))
    def _A_setup():
        B, Sq, D = 2, 1, 576
        Hq, Hkv, Sk, Dh = 32, 16, 32768, 128
        assert Hq % Hkv == 0, (Hq, Hkv)
        return {
            "x": _w((lambda *s: torch.randn(*s, dtype=torch.bfloat16) * 0.2)(B, Sq, D)),
            "k_cache": _w((lambda *s: torch.randn(*s, dtype=torch.bfloat16) * 1.6)(B, Hkv, Sk, Dh)),
            "v_cache": _w((lambda *s: torch.randn(*s, dtype=torch.bfloat16) * 1.6)(B, Hkv, Sk, Dh)),
            "wq": _w((lambda *s: torch.randn(*s, dtype=torch.bfloat16) * 1.6)(D, Hq * Dh) * (D ** -0.5)),
            "wo": _w((lambda *s: torch.randn(*s, dtype=torch.bfloat16) * 1.6)(Hq * Dh, D) * ((Hq * Dh) ** -0.5)),
        }
    _A_in = _A_setup()

    def _B_setup():
        B, S, D, F = 2, 1, 576, 4608
        return {
            "x": _w((lambda *s: torch.randn(*s, dtype=torch.bfloat16) * 0.2)(B, S, D)),
            "W_gate": _w((lambda *s: torch.randn(*s, dtype=torch.bfloat16) * 0.8)(D, F) * (2.0 / D) ** 0.5),
            "W_up": _w((lambda *s: torch.randn(*s, dtype=torch.bfloat16) * 0.8)(D, F) * (2.0 / D) ** 0.5),
            "W_down": _w((lambda *s: torch.randn(*s, dtype=torch.bfloat16) * 0.8)(F, D) * (1.0 / F) ** 0.5),
        }
    _B_in = _B_setup()

    return {
        "A_x": _A_in["x"],
        "A_k_cache": _A_in["k_cache"],
        "A_v_cache": _A_in["v_cache"],
        "A_wq": _A_in["wq"],
        "A_wo": _A_in["wo"],
        "B_x": _B_in["x"],
        "B_W_gate": _B_in["W_gate"],
        "B_W_up": _B_in["W_up"],
        "B_W_down": _B_in["W_down"],
    }

def reference(A_x, A_k_cache, A_v_cache, A_wq, A_wo, B_x, B_W_gate, B_W_up, B_W_down):
    def _A_ref(x, k_cache, v_cache, wq, wo):
        B, Sq, D = x.shape
        Hq, Dh = 32, 128
        Hkv, Sk = k_cache.shape[1], k_cache.shape[2]
        W = min(4096, max(256, Sk // 4))
        rep = Hq // Hkv
        q = (lambda x, *d: x.permute(*d))((x @ wq).reshape(B, Sq, Hq, Dh), 0, 2, 1, 3)
        k = (lambda x, n, axis: torch.repeat_interleave(x, n, dim=axis))(k_cache[:, :, Sk - W:, :], rep, axis=1)
        v = (lambda x, n, axis: torch.repeat_interleave(x, n, dim=axis))(v_cache[:, :, Sk - W:, :], rep, axis=1)
        scores = torch.einsum("bhqd,bhkd->bhqk", q, k) * (Dh ** -0.5)
        p = _softmax(scores, axis=-1)
        o = torch.einsum("bhqk,bhkd->bhqd", p, v)
        return (lambda x, *d: x.permute(*d))(o, 0, 2, 1, 3).reshape(B, Sq, Hq * Dh) @ wo

    def _B_ref(x, W_gate, W_up, W_down):
        gate = torch.einsum("bsd,df->bsf", x, W_gate)
        up = torch.einsum("bsd,df->bsf", x, W_up)
        gate = gate * (lambda x, dt: x.to(dt))(gate > 0, gate.dtype)
        h = gate * up
        return torch.einsum("bsf,fd->bsd", h, W_down)

    x = A_x
    xn = _layernorm(x, axis=-1)
    s = _A_ref(xn, A_k_cache, A_v_cache, A_wq, A_wo)
    g = _silu(_B_ref(xn, B_W_gate, B_W_up, B_W_down))
    return x + s * g
```

```asm
; @launch grid=(256,1,1) block=(1024,1,1) lds=159744
.amdgcn_target "amdgcn-amd-amdhsa--gfx950"
.text
.globl recurrent_scan__sliding_block_cached__glu_gated_reglu__decode_kernel
.p2align 8
.type recurrent_scan__sliding_block_cached__glu_gated_reglu__decode_kernel,@function
recurrent_scan__sliding_block_cached__glu_gated_reglu__decode_kernel:
    s_cmp_ge_u32 s2, 256
    s_cbranch_scc1 L_end
    s_load_dwordx16 s[8:23], s[0:1], 0
    s_load_dwordx8 s[24:31], s[0:1], 64
    v_readfirstlane_b32 s3, v0
    v_and_b32 v0, 63, v0
    s_lshr_b32 s3, s3, 6
    s_cmp_ge_u32 s3, 8
    s_cbranch_scc1 L_A
    s_and_b32 s4, s2, 7
    s_lshl_b32 s4, s4, 1
    s_lshr_b32 s5, s2, 7
    s_add_u32 s4, s4, s5
    s_bfe_u32 s5, s2, 0x40003
    v_and_b32 v2, 15, v0
    v_lshrrev_b32 v3, 4, v0
    s_mul_i32 s53, s4, 9
    s_add_u32 s53, s53, s5
    s_mul_i32 s51, s53, 171
    s_lshr_b32 s51, s51, 10
    s_mul_i32 s52, s51, 6
    s_sub_u32 s52, s53, s52
    s_setprio 3
    s_sub_u32 s44, s5, 9
    s_lshl_b32 s59, s4, 3
    s_add_u32 s59, s59, s44
    s_add_u32 s59, s59, 144
    s_movk_i32 s49, 0x2000
    s_cmp_lt_u32 s5, 9
    s_cselect_b32 s44, s52, s44
    s_cselect_b32 s55, 9216, s49
    s_cselect_b32 s59, s53, s59
    s_cmp_ge_u32 s44, 3
    s_cselect_b32 s62, 1, 0
    s_mul_i32 s47, s62, 3
    s_sub_u32 s44, s44, s47
    s_lshr_b32 s49, s3, 2
    s_cmp_eq_u32 s5, 15
    s_cselect_b32 s49, s49, s62
    s_lshl_b32 s49, s49, 8
    s_lshl_b32 s48, s4, 9
    s_add_u32 s48, s48, s49
    s_mul_i32 s47, s51, 384
    s_cmp_lt_u32 s5, 9
    s_cselect_b32 s47, s47, s48
    s_and_b32 s58, s3, 3
    s_mul_i32 s58, s58, 144
    s_add_u32 s58, s58, 5
    s_lshl_b32 s44, s44, 3
    s_add_u32 s54, s3, s44
    s_mul_i32 s54, s54, 24
    s_cmp_eq_u32 s5, 15
    s_cselect_b32 s54, s58, s54
    s_mul_i32 s44, s54, s55
    s_cselect_b32 s55, 0xc000, s55
    s_add_u32 s44, s44, s47
    s_mul_i32 s47, s55, 6
    v_mul_u32_u24 v10, s47, v3
    v_lshl_add_u32 v10, v2, 4, v10
    v_lshrrev_b32 v11, 3, v2
    v_mul_u32_u24 v11, 9088, v11
    v_add_u32 v11, v10, v11
    s_mul_i32 s34, s55, 23
    s_add_u32 s34, s34, 256
    s_mov_b32 s35, 0x20000
    s_cmp_eq_u32 s62, 0
    s_waitcnt lgkmcnt(0)
    s_cselect_b64 s[56:57], s[20:21], s[22:23]
    s_cmp_lt_u32 s5, 9
    s_cselect_b64 s[56:57], s[56:57], s[14:15]
    s_add_u32 s32, s56, s44
    s_addc_u32 s33, s57, 0
    buffer_load_dwordx4 v[64:67], v10, s[32:35], 0 offen nt
    buffer_load_dwordx4 v[68:71], v10, s[32:35], s55 offen nt
    s_cmp_lg_u32 s3, 0
    s_cbranch_scc1 L_B_nx
    s_mov_b32 s40, s8
    s_mov_b32 s41, s9
    s_mov_b32 s42, 2304
    s_mov_b32 s43, 0x20000
    v_lshrrev_b32 v22, 5, v0
    v_and_b32 v23, 31, v0
    v_mul_u32_u24 v113, 1152, v22
    v_mad_u32_u24 v113, v23, 36, v113
    buffer_load_dwordx4 v[104:107], v113, s[40:43], 0 offen
    buffer_load_dwordx4 v[108:111], v113, s[40:43], 0 offen offset:16
    buffer_load_dword v112, v113, s[40:43], 0 offen offset:32
L_B_nx:
    s_lshl_b32 s44, s55, 1
    s_cmp_ge_u32 s5, 9
    s_cbranch_scc1 L_B_dq
    s_add_u32 s34, s34, 128
    buffer_load_dwordx4 v[88:91], v11, s[32:35], 0 offen offset:256 nt
    s_barrier
    s_waitcnt vmcnt(2)
    s_mov_b32 s44, 18432
    buffer_load_dwordx4 v[72:75], v10, s[32:35], s44 offen nt
    s_waitcnt vmcnt(2)
    s_mov_b32 s44, 27648
    buffer_load_dwordx4 v[76:79], v10, s[32:35], s44 offen nt
    s_waitcnt vmcnt(2)
    s_mov_b32 s44, 18432
    buffer_load_dwordx4 v[92:95], v11, s[32:35], s44 offen offset:256 nt
    s_waitcnt vmcnt(2)
    s_mov_b32 s44, 36864
    buffer_load_dwordx4 v[80:83], v10, s[32:35], s44 offen nt
    s_waitcnt vmcnt(2)
    s_mov_b32 s44, 46080
    buffer_load_dwordx4 v[84:87], v10, s[32:35], s44 offen nt
    s_waitcnt vmcnt(2)
    s_mov_b32 s44, 36864
    buffer_load_dwordx4 v[96:99], v11, s[32:35], s44 offen offset:256 nt
    s_branch L_B_isd
L_B_dq:
    buffer_load_dwordx4 v[72:75], v10, s[32:35], s44 offen nt
    s_add_u32 s44, s44, s55
    s_barrier
    s_waitcnt vmcnt(2)
    buffer_load_dwordx4 v[76:79], v10, s[32:35], s44 offen nt
    s_add_u32 s44, s44, s55
    s_waitcnt vmcnt(2)
    buffer_load_dwordx4 v[80:83], v10, s[32:35], s44 offen nt
    s_add_u32 s44, s44, s55
    s_cmp_lg_u32 s5, 15
    s_cbranch_scc1 L_B_isd
    s_waitcnt vmcnt(2)
    buffer_load_dwordx4 v[84:87], v10, s[32:35], s44 offen nt
L_B_isd:
    s_setprio 0
    v_mov_b32 v15, 131072
    v_mov_b32 v18, 1
    s_and_b32 s44, s3, 3
    s_lshl_b32 s44, s44, 2
    v_add_u32 v9, s44, v15
    s_waitcnt vmcnt(1)
    s_mov_b64 exec, 1
    ds_add_u32 v9, v18 offset:128
    s_mov_b64 exec, -1
    s_cmp_lg_u32 s3, 0
    s_cbranch_scc1 L_B_noln
    v_add_u32 v113, 132096, v113
    s_mov_b32 s50, 0xffff0000
    s_mov_b32 s48, 987991609
    s_mov_b32 s49, 925353388
    s_waitcnt vmcnt(3)
    v_lshlrev_b32 v22, 16, v104
    v_and_b32 v23, s50, v104
    v_lshlrev_b32 v24, 16, v105
    v_and_b32 v25, s50, v105
    v_lshlrev_b32 v26, 16, v106
    v_and_b32 v27, s50, v106
    v_lshlrev_b32 v28, 16, v107
    v_and_b32 v29, s50, v107
    v_lshlrev_b32 v30, 16, v108
    v_and_b32 v31, s50, v108
    v_lshlrev_b32 v32, 16, v109
    v_and_b32 v33, s50, v109
    v_lshlrev_b32 v34, 16, v110
    v_and_b32 v35, s50, v110
    v_lshlrev_b32 v36, 16, v111
    v_and_b32 v37, s50, v111
    v_lshlrev_b32 v38, 16, v112
    v_and_b32 v39, s50, v112
    v_pk_add_f32 v[40:41], v[22:23], v[24:25]
    v_pk_add_f32 v[40:41], v[40:41], v[26:27]
    v_pk_add_f32 v[40:41], v[40:41], v[28:29]
    v_pk_add_f32 v[40:41], v[40:41], v[30:31]
    v_pk_add_f32 v[40:41], v[40:41], v[32:33]
    v_pk_add_f32 v[40:41], v[40:41], v[34:35]
    v_pk_add_f32 v[40:41], v[40:41], v[36:37]
    v_pk_add_f32 v[40:41], v[40:41], v[38:39]
    v_add_f32 v40, v40, v41
    s_nop 1
    v_add_f32_dpp v40, v40, v40 quad_perm:[1,0,3,2] row_mask:0xf bank_mask:0xf
    s_nop 1
    v_add_f32_dpp v40, v40, v40 quad_perm:[2,3,0,1] row_mask:0xf bank_mask:0xf
    s_nop 1
    v_add_f32_dpp v40, v40, v40 row_half_mirror row_mask:0xf bank_mask:0xf
    s_nop 1
    v_add_f32_dpp v40, v40, v40 row_mirror row_mask:0xf bank_mask:0xf
    v_mov_b32 v41, v40
    s_nop 1
    v_permlane16_swap_b32 v40, v41
    v_add_f32 v40, v40, v41
    v_mul_f32 v40, s48, v40
    v_mov_b32 v42, 0
    v_mov_b32 v43, 0
    v_sub_f32 v44, v22, v40
    v_sub_f32 v45, v23, v40
    v_fmac_f32 v42, v44, v44
    v_fmac_f32 v43, v45, v45
    v_sub_f32 v44, v24, v40
    v_sub_f32 v45, v25, v40
    v_fmac_f32 v42, v44, v44
    v_fmac_f32 v43, v45, v45
    v_sub_f32 v44, v26, v40
    v_sub_f32 v45, v27, v40
    v_fmac_f32 v42, v44, v44
    v_fmac_f32 v43, v45, v45
    v_sub_f32 v44, v28, v40
    v_sub_f32 v45, v29, v40
    v_fmac_f32 v42, v44, v44
    v_fmac_f32 v43, v45, v45
    v_sub_f32 v44, v30, v40
    v_sub_f32 v45, v31, v40
    v_fmac_f32 v42, v44, v44
    v_fmac_f32 v43, v45, v45
    v_sub_f32 v44, v32, v40
    v_sub_f32 v45, v33, v40
    v_fmac_f32 v42, v44, v44
    v_fmac_f32 v43, v45, v45
    v_sub_f32 v44, v34, v40
    v_sub_f32 v45, v35, v40
    v_fmac_f32 v42, v44, v44
    v_fmac_f32 v43, v45, v45
    v_sub_f32 v44, v36, v40
    v_sub_f32 v45, v37, v40
    v_fmac_f32 v42, v44, v44
    v_fmac_f32 v43, v45, v45
    v_sub_f32 v44, v38, v40
    v_sub_f32 v45, v39, v40
    v_fmac_f32 v42, v44, v44
    v_fmac_f32 v43, v45, v45
    v_add_f32 v42, v42, v43
    s_nop 1
    v_add_f32_dpp v42, v42, v42 quad_perm:[1,0,3,2] row_mask:0xf bank_mask:0xf
    s_nop 1
    v_add_f32_dpp v42, v42, v42 quad_perm:[2,3,0,1] row_mask:0xf bank_mask:0xf
    s_nop 1
    v_add_f32_dpp v42, v42, v42 row_half_mirror row_mask:0xf bank_mask:0xf
    s_nop 1
    v_add_f32_dpp v42, v42, v42 row_mirror row_mask:0xf bank_mask:0xf
    v_mov_b32 v43, v42
    s_nop 1
    v_permlane16_swap_b32 v42, v43
    v_add_f32 v42, v42, v43
    v_mul_f32 v42, s48, v42
    v_cvt_pk_bf16_f32 v40, v40, v42
    v_and_b32 v42, s50, v40
    v_lshlrev_b32 v40, 16, v40
    v_add_f32 v42, s49, v42
    v_cvt_pk_bf16_f32 v42, v42, v42
    v_and_b32 v42, s50, v42
    v_sqrt_f32 v42, v42
    s_nop 0
    v_cvt_pk_bf16_f32 v42, v42, v42
    v_and_b32 v42, s50, v42
    v_rcp_f32 v42, v42
    v_sub_f32 v22, v22, v40
    v_sub_f32 v23, v23, v40
    v_cvt_pk_bf16_f32 v104, v22, v23
    v_lshlrev_b32 v22, 16, v104
    v_and_b32 v23, s50, v104
    v_mul_f32 v22, v22, v42
    v_mul_f32 v23, v23, v42
    v_cvt_pk_bf16_f32 v104, v22, v23
    v_sub_f32 v24, v24, v40
    v_sub_f32 v25, v25, v40
    v_cvt_pk_bf16_f32 v105, v24, v25
    v_lshlrev_b32 v24, 16, v105
    v_and_b32 v25, s50, v105
    v_mul_f32 v24, v24, v42
    v_mul_f32 v25, v25, v42
    v_cvt_pk_bf16_f32 v105, v24, v25
    v_sub_f32 v26, v26, v40
    v_sub_f32 v27, v27, v40
    v_cvt_pk_bf16_f32 v106, v26, v27
    v_lshlrev_b32 v26, 16, v106
    v_and_b32 v27, s50, v106
    v_mul_f32 v26, v26, v42
    v_mul_f32 v27, v27, v42
    v_cvt_pk_bf16_f32 v106, v26, v27
    v_sub_f32 v28, v28, v40
    v_sub_f32 v29, v29, v40
    v_cvt_pk_bf16_f32 v107, v28, v29
    v_lshlrev_b32 v28, 16, v107
    v_and_b32 v29, s50, v107
    v_mul_f32 v28, v28, v42
    v_mul_f32 v29, v29, v42
    v_cvt_pk_bf16_f32 v107, v28, v29
    v_sub_f32 v30, v30, v40
    v_sub_f32 v31, v31, v40
    v_cvt_pk_bf16_f32 v108, v30, v31
    v_lshlrev_b32 v30, 16, v108
    v_and_b32 v31, s50, v108
    v_mul_f32 v30, v30, v42
    v_mul_f32 v31, v31, v42
    v_cvt_pk_bf16_f32 v108, v30, v31
    v_sub_f32 v32, v32, v40
    v_sub_f32 v33, v33, v40
    v_cvt_pk_bf16_f32 v109, v32, v33
    v_lshlrev_b32 v32, 16, v109
    v_and_b32 v33, s50, v109
    v_mul_f32 v32, v32, v42
    v_mul_f32 v33, v33, v42
    v_cvt_pk_bf16_f32 v109, v32, v33
    v_sub_f32 v34, v34, v40
    v_sub_f32 v35, v35, v40
    v_cvt_pk_bf16_f32 v110, v34, v35
    v_lshlrev_b32 v34, 16, v110
    v_and_b32 v35, s50, v110
    v_mul_f32 v34, v34, v42
    v_mul_f32 v35, v35, v42
    v_cvt_pk_bf16_f32 v110, v34, v35
    v_sub_f32 v36, v36, v40
    v_sub_f32 v37, v37, v40
    v_cvt_pk_bf16_f32 v111, v36, v37
    v_lshlrev_b32 v36, 16, v111
    v_and_b32 v37, s50, v111
    v_mul_f32 v36, v36, v42
    v_mul_f32 v37, v37, v42
    v_cvt_pk_bf16_f32 v111, v36, v37
    v_sub_f32 v38, v38, v40
    v_sub_f32 v39, v39, v40
    v_cvt_pk_bf16_f32 v112, v38, v39
    v_lshlrev_b32 v38, 16, v112
    v_and_b32 v39, s50, v112
    v_mul_f32 v38, v38, v42
    v_mul_f32 v39, v39, v42
    v_cvt_pk_bf16_f32 v112, v38, v39
    ds_write2_b32 v113, v104, v105 offset0:0 offset1:1
    ds_write2_b32 v113, v106, v107 offset0:2 offset1:3
    ds_write2_b32 v113, v108, v109 offset0:4 offset1:5
    ds_write2_b32 v113, v110, v111 offset0:6 offset1:7
    ds_write_b32 v113, v112 offset:32
    s_mov_b64 exec, 1
    ds_add_u32 v15, v18 offset:28
    s_mov_b64 exec, -1
L_B_noln:
    s_load_dword s7, s[30:31], 0
    s_mov_b32 s44, 1310720
    s_load_dword s58, s[30:31], s44
    v_and_b32 v8, 1, v2
    v_lshlrev_b32 v8, 4, v8
    v_mov_b32 v9, 0xffff
    v_lshlrev_b32 v9, v8, v9
    v_bfe_u32 v8, v2, 1, 2
    v_cmp_eq_u32 vcc, 0, v8
    s_nop 1
    v_cndmask_b32 v4, 0, v9, vcc
    v_cmp_eq_u32 vcc, 1, v8
    s_nop 1
    v_cndmask_b32 v5, 0, v9, vcc
    v_cmp_eq_u32 vcc, 2, v8
    s_nop 1
    v_cndmask_b32 v6, 0, v9, vcc
    v_cmp_eq_u32 vcc, 3, v8
    s_nop 1
    v_cndmask_b32 v7, 0, v9, vcc
    s_cmp_eq_u32 s5, 15
    s_cselect_b32 s44, 72, 12
    v_lshrrev_b32 v9, 3, v2
    v_mul_u32_u24 v9, 1152, v9
    v_mad_u32_u24 v9, v3, s44, v9
    s_lshl_b32 s44, s54, 1
    s_and_b32 s44, s44, -4
    s_add_u32 s44, s44, 132096
    v_add_u32 v9, s44, v9
    s_mov_b32 s48, 0x01000100
    s_mov_b32 s49, 0x03020302
    v_lshlrev_b32 v8, 4, v0
    v_lshlrev_b32 v12, 4, v2
    v_lshl_add_u32 v12, v3, 7, v12
    s_mul_i32 s44, s3, 1536
    s_add_u32 s44, s44, 139008
    v_add_u32 v13, s44, v8
    v_add_u32 v14, s44, v12
    v_mov_b32 v56, 0
    v_mov_b32 v57, 0
    v_mov_b32 v58, 0
    v_mov_b32 v59, 0
L_x_wait:
    ds_read_b32 v16, v15 offset:28
    s_waitcnt lgkmcnt(0)
    v_readfirstlane_b32 s44, v16
    s_nop 0
    s_cmp_ge_u32 s44, 1
    s_cbranch_scc1 L_x_wait_ok
    s_sleep 2
    s_branch L_x_wait
L_x_wait_ok:
    s_cmp_eq_u32 s5, 15
    s_cbranch_scc1 L_B_xs
    ds_read2_b32 v[24:25], v9 offset0:0 offset1:0
    ds_read2_b32 v[26:27], v9 offset0:1 offset1:1
    ds_read2_b32 v[28:29], v9 offset0:2 offset1:2
    s_branch L_B_xd
L_B_xs:
    ds_read2_b32 v[24:25], v9 offset0:0 offset1:3
    ds_read2_b32 v[26:27], v9 offset0:6 offset1:9
    ds_read2_b32 v[28:29], v9 offset0:12 offset1:15
    s_mov_b32 s48, s49
L_B_xd:
    s_waitcnt lgkmcnt(0)
    v_perm_b32 v31, v24, v24, s48
    v_and_b32 v32, v31, v4
    v_and_b32 v33, v31, v5
    v_and_b32 v34, v31, v6
    v_and_b32 v35, v31, v7
    v_perm_b32 v31, v25, v25, s49
    v_and_b32 v36, v31, v4
    v_and_b32 v37, v31, v5
    v_and_b32 v38, v31, v6
    v_and_b32 v39, v31, v7
    v_perm_b32 v31, v26, v26, s48
    v_and_b32 v40, v31, v4
    v_and_b32 v41, v31, v5
    v_and_b32 v42, v31, v6
    v_and_b32 v43, v31, v7
    v_perm_b32 v31, v27, v27, s49
    v_and_b32 v44, v31, v4
    v_and_b32 v45, v31, v5
    v_and_b32 v46, v31, v6
    v_and_b32 v47, v31, v7
    v_perm_b32 v31, v28, v28, s48
    v_and_b32 v48, v31, v4
    v_and_b32 v49, v31, v5
    v_and_b32 v50, v31, v6
    v_and_b32 v51, v31, v7
    v_perm_b32 v31, v29, v29, s49
    v_and_b32 v52, v31, v4
    v_and_b32 v53, v31, v5
    v_and_b32 v54, v31, v6
    v_and_b32 v55, v31, v7
    s_waitcnt vmcnt(0)
    s_cmp_eq_u32 s5, 15
    s_cbranch_scc1 L_B_m5
    s_cmp_ge_u32 s5, 9
    s_cbranch_scc1 L_B_m0
    v_mfma_f32_16x16x32_bf16 v[60:63], v[32:35], v[88:91], 0
    v_mfma_f32_16x16x32_bf16 v[100:103], v[36:39], v[88:91], 0
    v_mfma_f32_16x16x32_bf16 v[60:63], v[40:43], v[92:95], v[60:63]
    v_mfma_f32_16x16x32_bf16 v[100:103], v[44:47], v[92:95], v[100:103]
    v_mfma_f32_16x16x32_bf16 v[60:63], v[48:51], v[96:99], v[60:63]
    v_mfma_f32_16x16x32_bf16 v[100:103], v[52:55], v[96:99], v[100:103]
    s_nop 7
    v_add_f32_dpp v60, v100, v60 row_ror:8 row_mask:0xf bank_mask:0xf
    v_add_f32_dpp v61, v101, v61 row_ror:8 row_mask:0xf bank_mask:0xf
    v_add_f32_dpp v62, v102, v62 row_ror:8 row_mask:0xf bank_mask:0xf
    v_add_f32_dpp v63, v103, v63 row_ror:8 row_mask:0xf bank_mask:0xf
L_B_m5:
    v_mfma_f32_16x16x32_bf16 v[56:59], v[52:55], v[84:87], v[56:59]
L_B_m0:
    v_mfma_f32_16x16x32_bf16 v[56:59], v[32:35], v[64:67], v[56:59]
    v_mfma_f32_16x16x32_bf16 v[56:59], v[36:39], v[68:71], v[56:59]
    v_mfma_f32_16x16x32_bf16 v[56:59], v[40:43], v[72:75], v[56:59]
    v_mfma_f32_16x16x32_bf16 v[56:59], v[44:47], v[76:79], v[56:59]
    v_mfma_f32_16x16x32_bf16 v[56:59], v[48:51], v[80:83], v[56:59]
    s_nop 7
    ds_write_b128 v13, v[56:59]
    s_mov_b32 exec_lo, 0x00ff00ff
    s_mov_b32 exec_hi, 0x00ff00ff
    ds_write_b128 v14, v[60:63] offset:1024
    s_mov_b64 exec, 1
    ds_add_u32 v15, v18 offset:12
    s_mov_b64 exec, -1
    s_mov_b32 s36, s30
    s_mov_b32 s37, s31
    s_mov_b32 s38, 2097152
    s_mov_b32 s39, 0x20000
    s_movk_i32 s45, 1023
    s_add_u32 s60, s7, 1
    s_xor_b32 s58, s58, s60
    s_and_b32 s58, s58, s45
    s_cselect_b32 s58, 0, 1
    s_add_u32 s60, s60, s58
    s_and_b32 s7, s60, s45
    v_mov_b32 v21, s7
    s_mov_b32 s46, 0
    s_cmp_lg_u32 s3, 7
    s_cbranch_scc1 L_B_q
    v_add_u32 v13, 139008, v8
    v_add_u32 v14, 139008, v12
    s_mul_i32 s56, s59, 1664
    s_add_u32 s56, s56, 851968
L_gu_wait:
    ds_read_b32 v16, v15 offset:12
    s_waitcnt lgkmcnt(0)
    v_readfirstlane_b32 s44, v16
    s_nop 0
    s_cmp_ge_u32 s44, 8
    s_cbranch_scc1 L_gu_wait_ok
    s_sleep 1
    s_branch L_gu_wait
L_gu_wait_ok:
    ds_read_b128 v[64:67], v13 offset:0
    ds_read_b128 v[68:71], v14 offset:1024
    ds_read_b128 v[72:75], v13 offset:1536
    ds_read_b128 v[76:79], v14 offset:2560
    ds_read_b128 v[80:83], v13 offset:3072
    ds_read_b128 v[84:87], v14 offset:4096
    ds_read_b128 v[88:91], v13 offset:4608
    ds_read_b128 v[92:95], v14 offset:5632
    s_waitcnt lgkmcnt(0)
    v_pk_add_f32 v[64:65], v[64:65], v[72:73]
    v_pk_add_f32 v[66:67], v[66:67], v[74:75]
    v_pk_add_f32 v[68:69], v[68:69], v[76:77]
    v_pk_add_f32 v[70:71], v[70:71], v[78:79]
    v_pk_add_f32 v[64:65], v[64:65], v[80:81]
    v_pk_add_f32 v[66:67], v[66:67], v[82:83]
    v_pk_add_f32 v[68:69], v[68:69], v[84:85]
    v_pk_add_f32 v[70:71], v[70:71], v[86:87]
    v_pk_add_f32 v[64:65], v[64:65], v[88:89]
    v_pk_add_f32 v[66:67], v[66:67], v[90:91]
    v_pk_add_f32 v[68:69], v[68:69], v[92:93]
    v_pk_add_f32 v[70:71], v[70:71], v[94:95]
    ds_read_b128 v[96:99], v13 offset:6144
    ds_read_b128 v[100:103], v14 offset:7168
    ds_read_b128 v[104:107], v13 offset:7680
    ds_read_b128 v[108:111], v14 offset:8704
    ds_read_b128 v[112:115], v13 offset:9216
    ds_read_b128 v[116:119], v14 offset:10240
    ds_read_b128 v[120:123], v13 offset:10752
    ds_read_b128 v[124:127], v14 offset:11776
    s_waitcnt lgkmcnt(0)
    v_pk_add_f32 v[96:97], v[96:97], v[104:105]
    v_pk_add_f32 v[98:99], v[98:99], v[106:107]
    v_pk_add_f32 v[100:101], v[100:101], v[108:109]
    v_pk_add_f32 v[102:103], v[102:103], v[110:111]
    v_pk_add_f32 v[96:97], v[96:97], v[112:113]
    v_pk_add_f32 v[98:99], v[98:99], v[114:115]
    v_pk_add_f32 v[100:101], v[100:101], v[116:117]
    v_pk_add_f32 v[102:103], v[102:103], v[118:119]
    v_pk_add_f32 v[96:97], v[96:97], v[120:121]
    v_pk_add_f32 v[98:99], v[98:99], v[122:123]
    v_pk_add_f32 v[100:101], v[100:101], v[124:125]
    v_pk_add_f32 v[102:103], v[102:103], v[126:127]
    s_cmp_lg_u32 s5, 15
    s_cbranch_scc1 L_B_pl
    v_add_u32 v64, 0x200, v64
    v_add_u32 v65, 0x200, v65
    v_add_u32 v66, 0x200, v66
    v_add_u32 v67, 0x200, v67
    v_bfi_b32 v64, s45, v21, v64
    v_bfi_b32 v65, s45, v21, v65
    v_bfi_b32 v66, s45, v21, v66
    v_bfi_b32 v67, s45, v21, v67
    buffer_store_dwordx4 v[64:67], v8, s[36:39], s56 offen offset:0 sc1
    v_add_u32 v96, 0x200, v96
    v_add_u32 v97, 0x200, v97
    v_add_u32 v98, 0x200, v98
    v_add_u32 v99, 0x200, v99
    v_bfi_b32 v96, s45, v21, v96
    v_bfi_b32 v97, s45, v21, v97
    v_bfi_b32 v98, s45, v21, v98
    v_bfi_b32 v99, s45, v21, v99
    buffer_store_dwordx4 v[96:99], v8, s[36:39], s56 offen offset:1664 sc1
    s_branch L_B_x1
L_B_pl:
    v_pk_add_f32 v[64:65], v[64:65], v[96:97]
    v_pk_add_f32 v[66:67], v[66:67], v[98:99]
    v_pk_add_f32 v[68:69], v[68:69], v[100:101]
    v_pk_add_f32 v[70:71], v[70:71], v[102:103]
    v_add_u32 v64, 0x200, v64
    v_add_u32 v65, 0x200, v65
    v_add_u32 v66, 0x200, v66
    v_add_u32 v67, 0x200, v67
    v_add_u32 v68, 0x200, v68
    v_add_u32 v69, 0x200, v69
    v_add_u32 v70, 0x200, v70
    v_add_u32 v71, 0x200, v71
    v_bfi_b32 v64, s45, v21, v64
    v_bfi_b32 v65, s45, v21, v65
    v_bfi_b32 v66, s45, v21, v66
    v_bfi_b32 v67, s45, v21, v67
    v_bfi_b32 v68, s45, v21, v68
    v_bfi_b32 v69, s45, v21, v69
    v_bfi_b32 v70, s45, v21, v70
    v_bfi_b32 v71, s45, v21, v71
    buffer_store_dwordx4 v[64:67], v8, s[36:39], s56 offen
    s_cmp_ge_u32 s5, 9
    s_cbranch_scc1 L_B_xcc
    s_mov_b32 exec_lo, 0x00ff00ff
    s_mov_b32 exec_hi, 0x00ff00ff
    buffer_store_dwordx4 v[68:71], v12, s[36:39], s56 offen offset:1024
L_B_xcc:
    s_getreg_b32 s44, hwreg(HW_REG_XCC_ID, 0, 4)
    s_lshl_b32 s44, s44, 16
    s_or_b32 s44, s44, s7
    s_mov_b64 exec, 0xff
    v_mov_b32 v72, s44
    v_mov_b32 v73, s44
    v_mov_b32 v74, s44
    v_mov_b32 v75, s44
    buffer_store_dwordx4 v[72:75], v8, s[36:39], s56 offen offset:1536
    s_mov_b64 exec, -1
    s_branch L_B_x1
L_B_q:
    s_cmp_lg_u32 s3, 0
    s_cbranch_scc1 L_B_x1
    v_lshrrev_b32 v10, 5, v0
    v_and_b32 v11, 31, v0
    v_mul_u32_u24 v9, 4992, v10
    v_lshl_add_u32 v9, v11, 4, v9
    v_mul_u32_u24 v13, 1664, v10
    v_lshl_add_u32 v13, v11, 4, v13
    s_mul_i32 s58, s4, 13312
    s_add_u32 s58, s58, 1091584
    s_lshr_b32 s47, s5, 3
    s_lshl_b32 s47, s47, 9
    s_add_u32 s54, s58, s47
    s_add_u32 s55, s54, 9984
    v_min_u32 v12, 5, v0
    v_mul_u32_u24 v12, 1664, v12
L_k_wait:
    ds_read_b32 v16, v15 offset:8
    s_waitcnt lgkmcnt(0)
    v_readfirstlane_b32 s44, v16
    s_nop 0
    s_cmp_ge_u32 s44, 5
    s_cbranch_scc1 L_k_wait_ok
    s_sleep 4
    s_branch L_k_wait
L_k_wait_ok:
L_qpoll:
    buffer_load_dwordx4 v[24:27], v9, s[36:39], s54 offen offset:0 sc1
    buffer_load_dwordx4 v[28:31], v9, s[36:39], s54 offen offset:1664 sc1
    buffer_load_dwordx4 v[32:35], v9, s[36:39], s54 offen offset:3328 sc1
    buffer_load_dwordx4 v[36:39], v13, s[36:39], s55 offen sc1
    buffer_load_dwordx4 v[40:43], v12, s[36:39], s58 offen offset:1536 sc1
    s_waitcnt vmcnt(0)
    v_xor_b32 v24, s7, v24
    v_xor_b32 v25, s7, v25
    v_xor_b32 v26, s7, v26
    v_xor_b32 v27, s7, v27
    v_xor_b32 v28, s7, v28
    v_xor_b32 v29, s7, v29
    v_xor_b32 v30, s7, v30
    v_xor_b32 v31, s7, v31
    v_xor_b32 v32, s7, v32
    v_xor_b32 v33, s7, v33
    v_xor_b32 v34, s7, v34
    v_xor_b32 v35, s7, v35
    v_xor_b32 v36, s7, v36
    v_xor_b32 v37, s7, v37
    v_xor_b32 v38, s7, v38
    v_xor_b32 v39, s7, v39
    v_xor_b32 v40, s7, v40
    v_xor_b32 v41, s7, v41
    v_xor_b32 v42, s7, v42
    v_xor_b32 v43, s7, v43
    v_or3_b32 v22, v24, v25, v26
    v_or3_b32 v22, v22, v27, v28
    v_or3_b32 v22, v22, v29, v30
    v_or3_b32 v22, v22, v31, v32
    v_or3_b32 v22, v22, v33, v34
    v_or3_b32 v22, v22, v35, v36
    v_or3_b32 v22, v22, v37, v38
    v_or3_b32 v22, v22, v39, v40
    v_or3_b32 v22, v22, v41, v42
    v_or_b32 v22, v22, v43
    v_and_b32 v22, s45, v22
    v_cmp_ne_u32 vcc, 0, v22
    s_cbranch_vccz L_qok
    s_sleep 8
    s_add_u32 s46, s46, 1
    s_and_b32 s44, s46, 255
    s_cbranch_scc1 L_qpoll
    buffer_wbl2 sc1
    buffer_inv sc1
    s_waitcnt vmcnt(0)
    s_cmp_le_u32 s46, 200000
    s_cbranch_scc1 L_qpoll
L_qok:
    v_pk_add_f32 v[24:25], v[24:25], v[28:29]
    v_pk_add_f32 v[26:27], v[26:27], v[30:31]
    v_pk_add_f32 v[24:25], v[24:25], v[32:33]
    v_pk_add_f32 v[26:27], v[26:27], v[34:35]
    v_pk_add_f32 v[24:25], v[24:25], v[36:37]
    v_pk_add_f32 v[26:27], v[26:27], v[38:39]
    v_cvt_pk_bf16_f32 v24, v24, v25
    v_cvt_pk_bf16_f32 v25, v26, v27
    v_lshlrev_b32 v9, 8, v10
    v_lshl_add_u32 v9, v2, 4, v9
    v_and_b32 v10, 1, v3
    v_lshl_add_u32 v9, v10, 3, v9
    v_add_u32 v9, 131072, v9
    ds_write_b64 v9, v[24:25] offset:512
    s_getreg_b32 s44, hwreg(HW_REG_XCC_ID, 0, 4)
    s_lshl_b32 s44, s44, 16
    v_cmp_ne_u32 vcc, s44, v40
    s_cbranch_vccz L_near
    s_mov_b64 exec, 1
    ds_add_u32 v15, v18 offset:32
    s_mov_b64 exec, -1
L_near:
    s_mov_b64 exec, 1
    ds_add_u32 v15, v18 offset:16
    s_mov_b64 exec, -1
L_B_x1:
    s_lshr_b32 s6, s5, 3
    s_lshl_b32 s6, s6, 4
    s_add_u32 s6, s6, s4
    s_lshl_b32 s6, s6, 23
    s_add_u32 s6, s6, 0x700000
    s_add_u32 s32, s12, s6
    s_addc_u32 s33, s13, 0
    s_mov_b32 s34, 1048576
    s_mov_b32 s35, 0x20000
    s_and_b32 s47, s5, 7
    s_lshl_b32 s47, s47, 15
    s_lshr_b32 s44, s3, 2
    s_lshl_b32 s44, s44, 6
    s_lshr_b32 s44, s44, 5
    s_lshl_b32 s44, s44, 18
    s_add_u32 s47, s47, s44
    s_lshr_b32 s44, s3, 2
    s_lshl_b32 s44, s44, 6
    s_add_u32 s49, s5, s4
    s_lshl_b32 s49, s49, 3
    s_add_u32 s44, s44, s49
    s_and_b32 s49, s3, 3
    s_add_u32 s44, s44, s49
    s_and_b32 s44, s44, 31
    s_lshl_b32 s44, s44, 10
    s_add_u32 s47, s47, s44
    s_lshl_b32 s44, s3, 2
    v_add_u32 v9, s44, v15
L_kd_wait:
    ds_read_b32 v16, v9 offset:80
    s_waitcnt lgkmcnt(0)
    v_readfirstlane_b32 s44, v16
    s_nop 0
    s_cmp_ge_u32 s44, 1
    s_cbranch_scc1 L_kd_wait_ok
    s_sleep 1
    s_branch L_kd_wait
L_kd_wait_ok:
    buffer_load_dwordx4 v[64:67], v8, s[32:35], s47 offen nt
    s_add_u32 s44, s47, 4096
    s_and_b32 s44, s44, 0x7c00
    s_andn2_b32 s47, s47, 0x7c00
    s_or_b32 s47, s47, s44
    buffer_load_dwordx4 v[68:71], v8, s[32:35], s47 offen nt
    s_add_u32 s44, s47, 4096
    s_and_b32 s44, s44, 0x7c00
    s_andn2_b32 s47, s47, 0x7c00
    s_or_b32 s47, s47, s44
    buffer_load_dwordx4 v[72:75], v8, s[32:35], s47 offen nt
    s_add_u32 s44, s47, 4096
    s_and_b32 s44, s44, 0x7c00
    s_andn2_b32 s47, s47, 0x7c00
    s_or_b32 s47, s47, s44
    buffer_load_dwordx4 v[76:79], v8, s[32:35], s47 offen nt
    s_add_u32 s44, s47, 4096
    s_and_b32 s44, s44, 0x7c00
    s_andn2_b32 s47, s47, 0x7c00
    s_or_b32 s47, s47, s44
    buffer_load_dwordx4 v[80:83], v8, s[32:35], s47 offen nt
    s_add_u32 s44, s47, 4096
    s_and_b32 s44, s44, 0x7c00
    s_andn2_b32 s47, s47, 0x7c00
    s_or_b32 s47, s47, s44
    buffer_load_dwordx4 v[84:87], v8, s[32:35], s47 offen nt
    s_add_u32 s44, s47, 4096
    s_and_b32 s44, s44, 0x7c00
    s_andn2_b32 s47, s47, 0x7c00
    s_or_b32 s47, s47, s44
    s_waitcnt vmcnt(5)
    buffer_load_dwordx4 v[88:91], v8, s[32:35], s47 offen nt
    s_add_u32 s44, s47, 4096
    s_and_b32 s44, s44, 0x7c00
    s_andn2_b32 s47, s47, 0x7c00
    s_or_b32 s47, s47, s44
    s_waitcnt vmcnt(5)
    buffer_load_dwordx4 v[92:95], v8, s[32:35], s47 offen nt
    s_add_u32 s44, s47, 4096
    s_and_b32 s44, s44, 0x7c00
    s_andn2_b32 s47, s47, 0x7c00
    s_or_b32 s47, s47, s44
    s_add_u32 s47, s47, 0x40000
    s_waitcnt vmcnt(5)
    buffer_load_dwordx4 v[96:99], v8, s[32:35], s47 offen nt
    s_add_u32 s44, s47, 4096
    s_and_b32 s44, s44, 0x7c00
    s_andn2_b32 s47, s47, 0x7c00
    s_or_b32 s47, s47, s44
    s_waitcnt vmcnt(5)
    buffer_load_dwordx4 v[100:103], v8, s[32:35], s47 offen nt
    s_add_u32 s44, s47, 4096
    s_and_b32 s44, s44, 0x7c00
    s_andn2_b32 s47, s47, 0x7c00
    s_or_b32 s47, s47, s44
    s_waitcnt vmcnt(5)
    buffer_load_dwordx4 v[104:107], v8, s[32:35], s47 offen nt
    s_add_u32 s44, s47, 4096
    s_and_b32 s44, s44, 0x7c00
    s_andn2_b32 s47, s47, 0x7c00
    s_or_b32 s47, s47, s44
    s_waitcnt vmcnt(5)
    buffer_load_dwordx4 v[108:111], v8, s[32:35], s47 offen nt
    s_add_u32 s44, s47, 4096
    s_and_b32 s44, s44, 0x7c00
    s_andn2_b32 s47, s47, 0x7c00
    s_or_b32 s47, s47, s44
    s_waitcnt vmcnt(5)
    buffer_load_dwordx4 v[112:115], v8, s[32:35], s47 offen nt
    s_add_u32 s44, s47, 4096
    s_and_b32 s44, s44, 0x7c00
    s_andn2_b32 s47, s47, 0x7c00
    s_or_b32 s47, s47, s44
    s_waitcnt vmcnt(5)
    buffer_load_dwordx4 v[116:119], v8, s[32:35], s47 offen nt
    s_add_u32 s44, s47, 4096
    s_and_b32 s44, s44, 0x7c00
    s_andn2_b32 s47, s47, 0x7c00
    s_or_b32 s47, s47, s44
    s_waitcnt vmcnt(5)
    buffer_load_dwordx4 v[120:123], v8, s[32:35], s47 offen nt
    s_add_u32 s44, s47, 4096
    s_and_b32 s44, s44, 0x7c00
    s_andn2_b32 s47, s47, 0x7c00
    s_or_b32 s47, s47, s44
    s_waitcnt vmcnt(5)
    buffer_load_dwordx4 v[124:127], v8, s[32:35], s47 offen nt
    s_mov_b64 exec, 1
    ds_add_u32 v15, v18 offset:40
    s_mov_b64 exec, -1
    s_cmp_ge_u32 s3, 4
    s_cbranch_scc1 L_v_done
    s_waitcnt vmcnt(4)
    s_mov_b64 exec, 1
    ds_add_u32 v9, v18 offset:96
    s_mov_b64 exec, -1
L_v_done:
    v_lshrrev_b32 v10, 3, v2
    v_lshlrev_b32 v10, 11, v10
    v_lshl_add_u32 v10, v3, 6, v10
    s_lshl_b32 s44, s3, 8
    s_add_u32 s44, s44, 134912
    v_add_u32 v10, s44, v10
    v_lshrrev_b32 v12, 5, v0
    v_lshlrev_b32 v12, 3, v12
    v_add_u32 v12, 134400, v12
    v_and_b32 v11, 7, v0
    v_lshl_add_u32 v11, v11, 4, v12
    s_lshl_b32 s44, s3, 4
    v_add_u32 v12, s44, v12
    s_mov_b32 s49, 1069066811
    v_add_u32 v13, 151552, v8
    s_lshl_b32 s44, s3, 10
    v_add_u32 v14, s44, v13
    s_lshl_b32 s56, s4, 4
    s_add_u32 s56, s56, s5
    s_lshl_b32 s56, s56, 10
    s_add_u32 s56, s56, 4096
L_p_wait:
    ds_read_b32 v16, v15 offset:0
    s_waitcnt lgkmcnt(0)
    v_readfirstlane_b32 s44, v16
    s_nop 0
    s_cmp_ge_u32 s44, 8
    s_cbranch_scc1 L_p_wait_ok
    s_sleep 1
    s_branch L_p_wait
L_p_wait_ok:
    ds_read_b128 v[40:43], v10 offset:0
    ds_read_b128 v[44:47], v10 offset:16
    ds_read_b128 v[48:51], v10 offset:32
    ds_read_b128 v[52:55], v10 offset:48
    ds_read_b32 v16, v11
    ds_read_b32 v17, v12
    ds_read_b32 v19, v15 offset:32
    s_waitcnt lgkmcnt(6)
    v_and_b32 v24, v40, v4
    v_and_b32 v25, v40, v5
    v_and_b32 v26, v40, v6
    v_and_b32 v27, v40, v7
    v_and_b32 v28, v41, v4
    v_and_b32 v29, v41, v5
    v_and_b32 v30, v41, v6
    v_and_b32 v31, v41, v7
    s_waitcnt vmcnt(15)
    v_mfma_f32_16x16x32_bf16 v[32:35], v[24:27], v[64:67], 0
    v_and_b32 v24, v42, v4
    v_and_b32 v25, v42, v5
    v_and_b32 v26, v42, v6
    v_and_b32 v27, v42, v7
    s_waitcnt vmcnt(14)
    v_mfma_f32_16x16x32_bf16 v[32:35], v[28:31], v[68:71], v[32:35]
    v_and_b32 v28, v43, v4
    v_and_b32 v29, v43, v5
    v_and_b32 v30, v43, v6
    v_and_b32 v31, v43, v7
    s_waitcnt vmcnt(13)
    v_mfma_f32_16x16x32_bf16 v[32:35], v[24:27], v[72:75], v[32:35]
    s_waitcnt lgkmcnt(0)
    v_max_f32_dpp v16, v16, v16 quad_perm:[1,0,3,2] row_mask:0xf bank_mask:0xf
    v_and_b32 v24, v44, v4
    v_and_b32 v25, v44, v5
    v_and_b32 v26, v44, v6
    v_and_b32 v27, v44, v7
    s_waitcnt vmcnt(12)
    v_mfma_f32_16x16x32_bf16 v[32:35], v[28:31], v[76:79], v[32:35]
    v_max_f32_dpp v16, v16, v16 quad_perm:[2,3,0,1] row_mask:0xf bank_mask:0xf
    v_and_b32 v28, v45, v4
    v_and_b32 v29, v45, v5
    v_and_b32 v30, v45, v6
    v_and_b32 v31, v45, v7
    s_waitcnt vmcnt(11)
    v_mfma_f32_16x16x32_bf16 v[32:35], v[24:27], v[80:83], v[32:35]
    v_max_f32_dpp v16, v16, v16 row_half_mirror row_mask:0xf bank_mask:0xf
    v_and_b32 v24, v46, v4
    v_and_b32 v25, v46, v5
    v_and_b32 v26, v46, v6
    v_and_b32 v27, v46, v7
    s_waitcnt vmcnt(10)
    v_mfma_f32_16x16x32_bf16 v[32:35], v[28:31], v[84:87], v[32:35]
    v_sub_f32 v17, v17, v16
    v_mul_f32 v17, s49, v17
    v_and_b32 v28, v47, v4
    v_and_b32 v29, v47, v5
    v_and_b32 v30, v47, v6
    v_and_b32 v31, v47, v7
    s_waitcnt vmcnt(9)
    v_mfma_f32_16x16x32_bf16 v[32:35], v[24:27], v[88:91], v[32:35]
    v_exp_f32 v17, v17
    v_and_b32 v24, v48, v4
    v_and_b32 v25, v48, v5
    v_and_b32 v26, v48, v6
    v_and_b32 v27, v48, v7
    s_waitcnt vmcnt(8)
    v_mfma_f32_16x16x32_bf16 v[32:35], v[28:31], v[92:95], v[32:35]
    v_readfirstlane_b32 s57, v19
    v_and_b32 v28, v49, v4
    v_and_b32 v29, v49, v5
    v_and_b32 v30, v49, v6
    v_and_b32 v31, v49, v7
    s_waitcnt vmcnt(7)
    v_mfma_f32_16x16x32_bf16 v[32:35], v[24:27], v[96:99], v[32:35]
    v_and_b32 v24, v50, v4
    v_and_b32 v25, v50, v5
    v_and_b32 v26, v50, v6
    v_and_b32 v27, v50, v7
    s_waitcnt vmcnt(6)
    v_mfma_f32_16x16x32_bf16 v[32:35], v[28:31], v[100:103], v[32:35]
    v_and_b32 v28, v51, v4
    v_and_b32 v29, v51, v5
    v_and_b32 v30, v51, v6
    v_and_b32 v31, v51, v7
    s_waitcnt vmcnt(5)
    v_mfma_f32_16x16x32_bf16 v[32:35], v[24:27], v[104:107], v[32:35]
    v_and_b32 v24, v52, v4
    v_and_b32 v25, v52, v5
    v_and_b32 v26, v52, v6
    v_and_b32 v27, v52, v7
    s_waitcnt vmcnt(4)
    v_mfma_f32_16x16x32_bf16 v[32:35], v[28:31], v[108:111], v[32:35]
    v_and_b32 v28, v53, v4
    v_and_b32 v29, v53, v5
    v_and_b32 v30, v53, v6
    v_and_b32 v31, v53, v7
    s_waitcnt vmcnt(3)
    v_mfma_f32_16x16x32_bf16 v[32:35], v[24:27], v[112:115], v[32:35]
    v_and_b32 v24, v54, v4
    v_and_b32 v25, v54, v5
    v_and_b32 v26, v54, v6
    v_and_b32 v27, v54, v7
    s_waitcnt vmcnt(2)
    v_mfma_f32_16x16x32_bf16 v[32:35], v[28:31], v[116:119], v[32:35]
    v_and_b32 v28, v55, v4
    v_and_b32 v29, v55, v5
    v_and_b32 v30, v55, v6
    v_and_b32 v31, v55, v7
    s_waitcnt vmcnt(1)
    v_mfma_f32_16x16x32_bf16 v[32:35], v[24:27], v[120:123], v[32:35]
    s_waitcnt vmcnt(0)
    v_mfma_f32_16x16x32_bf16 v[32:35], v[28:31], v[124:127], v[32:35]
    s_nop 7
    v_pk_mul_f32 v[32:33], v[32:33], v[16:17] op_sel:[0,1]
    v_pk_mul_f32 v[34:35], v[34:35], v[16:17] op_sel:[0,1]
    ds_write_b128 v14, v[32:35]
    s_mov_b64 exec, 1
    ds_add_rtn_u32 v20, v15, v18 offset:4
    s_mov_b64 exec, -1
    ds_read_b128 v[64:67], v13 offset:0
    ds_read_b128 v[68:71], v13 offset:1024
    ds_read_b128 v[72:75], v13 offset:2048
    ds_read_b128 v[76:79], v13 offset:3072
    ds_read_b128 v[80:83], v13 offset:4096
    ds_read_b128 v[84:87], v13 offset:5120
    ds_read_b128 v[88:91], v13 offset:6144
    ds_read_b128 v[92:95], v13 offset:7168
    s_waitcnt lgkmcnt(8)
    v_readfirstlane_b32 s44, v20
    s_nop 0
    s_cmp_lg_u32 s44, 7
    s_cbranch_scc1 L_exit
    s_waitcnt lgkmcnt(6)
    v_pk_add_f32 v[64:65], v[64:65], v[68:69]
    v_pk_add_f32 v[66:67], v[66:67], v[70:71]
    s_waitcnt lgkmcnt(4)
    v_pk_add_f32 v[72:73], v[72:73], v[76:77]
    v_pk_add_f32 v[74:75], v[74:75], v[78:79]
    v_pk_add_f32 v[64:65], v[64:65], v[72:73]
    v_pk_add_f32 v[66:67], v[66:67], v[74:75]
    s_waitcnt lgkmcnt(2)
    v_pk_add_f32 v[80:81], v[80:81], v[84:85]
    v_pk_add_f32 v[82:83], v[82:83], v[86:87]
    v_pk_add_f32 v[64:65], v[64:65], v[80:81]
    v_pk_add_f32 v[66:67], v[66:67], v[82:83]
    s_waitcnt lgkmcnt(0)
    v_pk_add_f32 v[88:89], v[88:89], v[92:93]
    v_pk_add_f32 v[90:91], v[90:91], v[94:95]
    v_pk_add_f32 v[64:65], v[64:65], v[88:89]
    v_pk_add_f32 v[66:67], v[66:67], v[90:91]
    v_bfi_b32 v64, s45, v21, v64
    v_bfi_b32 v65, s45, v21, v65
    v_bfi_b32 v66, s45, v21, v66
    v_bfi_b32 v67, s45, v21, v67
    s_cmp_lg_u32 s57, 0
    s_cbranch_scc1 L_ofar
    buffer_store_dwordx4 v[64:67], v8, s[36:39], s56 offen
L_odone:
    s_cmp_ge_u32 s5, 9
    s_cbranch_scc1 L_exit
    s_barrier
    s_endpgm
L_ofar:
    buffer_store_dwordx4 v[64:67], v8, s[36:39], s56 offen sc1
    s_branch L_odone
L_A:
    s_and_b32 s4, s2, 7
    s_lshl_b32 s4, s4, 1
    s_lshr_b32 s5, s2, 7
    s_add_u32 s4, s4, s5
    s_bfe_u32 s5, s2, 0x40003
    v_and_b32 v2, 15, v0
    v_lshrrev_b32 v3, 4, v0
    s_mul_i32 s53, s4, 9
    s_add_u32 s53, s53, s5
    s_mul_i32 s51, s53, 171
    s_lshr_b32 s51, s51, 10
    s_mul_i32 s52, s51, 6
    s_sub_u32 s52, s53, s52
    s_sub_u32 s3, s3, 8
    v_mov_b32 v15, 131072
    v_mov_b32 v18, 1
    s_cmp_lg_u32 s3, 0
    s_cbranch_scc1 L_A_n0
    v_lshl_add_u32 v9, v0, 3, v15
    v_mov_b32 v10, 0
    v_mov_b32 v11, 0
    ds_write_b64 v9, v[10:11]
L_A_n0:
    s_lshr_b32 s6, s5, 3
    s_lshl_b32 s6, s6, 4
    s_add_u32 s6, s6, s4
    s_lshl_b32 s6, s6, 23
    s_add_u32 s6, s6, 0x700000
    v_xor_b32 v4, v2, v3
    v_lshlrev_b32 v4, 4, v4
    v_lshl_add_u32 v4, v3, 8, v4
    v_xor_b32 v5, 64, v4
    v_xor_b32 v6, 0x80, v4
    v_xor_b32 v7, 0xc0, v4
    s_lshl_b32 s47, s3, 14
    s_mov_b32 m0, s47
    s_and_b32 s48, s5, 7
    s_lshl_b32 s48, s48, 15
    s_lshr_b32 s44, s3, 2
    s_lshl_b32 s44, s44, 6
    s_lshr_b32 s44, s44, 5
    s_lshl_b32 s44, s44, 18
    s_add_u32 s48, s48, s44
    s_lshr_b32 s44, s3, 2
    s_lshl_b32 s44, s44, 6
    s_add_u32 s49, s5, s4
    s_lshl_b32 s49, s49, 3
    s_add_u32 s44, s44, s49
    s_and_b32 s49, s3, 3
    s_add_u32 s44, s44, s49
    s_and_b32 s44, s44, 31
    s_lshl_b32 s44, s44, 10
    s_add_u32 s48, s48, s44
    s_lshl_b32 s44, s3, 2
    v_add_u32 v53, s44, v15
    s_mov_b32 s46, 0
    s_waitcnt lgkmcnt(0)
    s_add_u32 s32, s10, s6
    s_addc_u32 s33, s11, 0
    s_mov_b32 s34, 1048576
    s_mov_b32 s35, 0x20000
    s_load_dword s7, s[30:31], 0
    s_mov_b32 s44, 1310720
    s_load_dword s58, s[30:31], s44
    s_barrier
    s_cmp_lt_u32 s3, 4
    s_cbranch_scc1 L_pd_wait
L_kc_wait:
    ds_read_b32 v16, v53 offset:48
    s_waitcnt lgkmcnt(0)
    v_readfirstlane_b32 s44, v16
    s_nop 0
    s_cmp_ge_u32 s44, 1
    s_cbranch_scc1 L_kc_wait_ok
    s_sleep 1
    s_branch L_kc_wait
L_kc_wait_ok:
    s_branch L_pd_wait_ok
L_pd_wait:
    ds_read_b32 v16, v53 offset:128
    s_waitcnt lgkmcnt(0)
    v_readfirstlane_b32 s44, v16
    s_nop 0
    s_cmp_ge_u32 s44, 2
    s_cbranch_scc1 L_pd_wait_ok
    s_sleep 1
    s_branch L_pd_wait
L_pd_wait_ok:
    buffer_load_dwordx4 v4, s[32:35], s48 offen nt lds
    s_add_u32 m0, m0, 0x400
    s_add_u32 s44, s48, 4096
    s_and_b32 s44, s44, 0x7c00
    s_andn2_b32 s48, s48, 0x7c00
    s_or_b32 s48, s48, s44
    buffer_load_dwordx4 v5, s[32:35], s48 offen nt lds
    s_add_u32 m0, m0, 0x400
    s_add_u32 s44, s48, 4096
    s_and_b32 s44, s44, 0x7c00
    s_andn2_b32 s48, s48, 0x7c00
    s_or_b32 s48, s48, s44
    buffer_load_dwordx4 v6, s[32:35], s48 offen nt lds
    s_add_u32 m0, m0, 0x400
    s_add_u32 s44, s48, 4096
    s_and_b32 s44, s44, 0x7c00
    s_andn2_b32 s48, s48, 0x7c00
    s_or_b32 s48, s48, s44
    buffer_load_dwordx4 v7, s[32:35], s48 offen nt lds
    s_add_u32 m0, m0, 0x400
    s_add_u32 s44, s48, 4096
    s_and_b32 s44, s44, 0x7c00
    s_andn2_b32 s48, s48, 0x7c00
    s_or_b32 s48, s48, s44
    buffer_load_dwordx4 v4, s[32:35], s48 offen nt lds
    s_add_u32 m0, m0, 0x400
    s_add_u32 s44, s48, 4096
    s_and_b32 s44, s44, 0x7c00
    s_andn2_b32 s48, s48, 0x7c00
    s_or_b32 s48, s48, s44
    s_waitcnt vmcnt(4)
    buffer_load_dwordx4 v5, s[32:35], s48 offen nt lds
    s_add_u32 m0, m0, 0x400
    s_add_u32 s44, s48, 4096
    s_and_b32 s44, s44, 0x7c00
    s_andn2_b32 s48, s48, 0x7c00
    s_or_b32 s48, s48, s44
    s_waitcnt vmcnt(4)
    buffer_load_dwordx4 v6, s[32:35], s48 offen nt lds
    s_add_u32 m0, m0, 0x400
    s_add_u32 s44, s48, 4096
    s_and_b32 s44, s44, 0x7c00
    s_andn2_b32 s48, s48, 0x7c00
    s_or_b32 s48, s48, s44
    s_waitcnt vmcnt(4)
    buffer_load_dwordx4 v7, s[32:35], s48 offen nt lds
    s_add_u32 m0, m0, 0x400
    s_add_u32 s44, s48, 4096
    s_and_b32 s44, s44, 0x7c00
    s_andn2_b32 s48, s48, 0x7c00
    s_or_b32 s48, s48, s44
    s_add_u32 s48, s48, 0x40000
    s_waitcnt vmcnt(4)
    buffer_load_dwordx4 v4, s[32:35], s48 offen nt lds
    s_add_u32 m0, m0, 0x400
    s_add_u32 s44, s48, 4096
    s_and_b32 s44, s44, 0x7c00
    s_andn2_b32 s48, s48, 0x7c00
    s_or_b32 s48, s48, s44
    s_mov_b64 exec, 1
    ds_add_u32 v15, v18 offset:8
    s_mov_b64 exec, -1
    s_waitcnt vmcnt(4)
    buffer_load_dwordx4 v5, s[32:35], s48 offen nt lds
    s_add_u32 m0, m0, 0x400
    s_add_u32 s44, s48, 4096
    s_and_b32 s44, s44, 0x7c00
    s_andn2_b32 s48, s48, 0x7c00
    s_or_b32 s48, s48, s44
    s_waitcnt vmcnt(4)
    buffer_load_dwordx4 v6, s[32:35], s48 offen nt lds
    s_add_u32 m0, m0, 0x400
    s_add_u32 s44, s48, 4096
    s_and_b32 s44, s44, 0x7c00
    s_andn2_b32 s48, s48, 0x7c00
    s_or_b32 s48, s48, s44
    s_waitcnt vmcnt(4)
    buffer_load_dwordx4 v7, s[32:35], s48 offen nt lds
    s_add_u32 m0, m0, 0x400
    s_add_u32 s44, s48, 4096
    s_and_b32 s44, s44, 0x7c00
    s_andn2_b32 s48, s48, 0x7c00
    s_or_b32 s48, s48, s44
    s_waitcnt vmcnt(4)
    buffer_load_dwordx4 v4, s[32:35], s48 offen nt lds
    s_add_u32 m0, m0, 0x400
    s_add_u32 s44, s48, 4096
    s_and_b32 s44, s44, 0x7c00
    s_andn2_b32 s48, s48, 0x7c00
    s_or_b32 s48, s48, s44
    s_waitcnt vmcnt(4)
    buffer_load_dwordx4 v5, s[32:35], s48 offen nt lds
    s_add_u32 m0, m0, 0x400
    s_add_u32 s44, s48, 4096
    s_and_b32 s44, s44, 0x7c00
    s_andn2_b32 s48, s48, 0x7c00
    s_or_b32 s48, s48, s44
    s_waitcnt vmcnt(4)
    buffer_load_dwordx4 v6, s[32:35], s48 offen nt lds
    s_add_u32 m0, m0, 0x400
    s_add_u32 s44, s48, 4096
    s_and_b32 s44, s44, 0x7c00
    s_andn2_b32 s48, s48, 0x7c00
    s_or_b32 s48, s48, s44
    s_waitcnt vmcnt(4)
    buffer_load_dwordx4 v7, s[32:35], s48 offen nt lds
    s_waitcnt vmcnt(4)
    s_mov_b64 exec, 1
    ds_add_u32 v53, v18 offset:64
    s_mov_b64 exec, -1
L_k_done:
    s_mov_b32 s36, s30
    s_mov_b32 s37, s31
    s_mov_b32 s38, 2097152
    s_mov_b32 s39, 0x20000
    v_or_b32 v4, 0, v3
    v_xor_b32 v4, v4, v2
    v_lshlrev_b32 v4, 4, v4
    v_lshl_add_u32 v4, v2, 8, v4
    v_add_u32 v4, s47, v4
    v_or_b32 v5, 4, v3
    v_xor_b32 v5, v5, v2
    v_lshlrev_b32 v5, 4, v5
    v_lshl_add_u32 v5, v2, 8, v5
    v_add_u32 v5, s47, v5
    v_or_b32 v6, 8, v3
    v_xor_b32 v6, v6, v2
    v_lshlrev_b32 v6, 4, v6
    v_lshl_add_u32 v6, v2, 8, v6
    v_add_u32 v6, s47, v6
    v_or_b32 v7, 12, v3
    v_xor_b32 v7, v7, v2
    v_lshlrev_b32 v7, 4, v7
    v_lshl_add_u32 v7, v2, 8, v7
    v_add_u32 v7, s47, v7
    v_and_b32 v12, 1, v2
    v_lshlrev_b32 v12, 8, v12
    v_lshl_add_u32 v12, v3, 4, v12
    v_add_u32 v12, 131584, v12
    v_mov_b32 v13, 131328
    v_lshrrev_b32 v14, 2, v2
    v_cmp_eq_u32 vcc, 0, v14
    s_nop 1
    v_cndmask_b32 v8, v13, v12, vcc
    v_cmp_eq_u32 vcc, 1, v14
    s_nop 1
    v_cndmask_b32 v9, v13, v12, vcc
    v_cmp_eq_u32 vcc, 2, v14
    s_nop 1
    v_cndmask_b32 v10, v13, v12, vcc
    v_cmp_eq_u32 vcc, 3, v14
    s_nop 1
    v_cndmask_b32 v11, v13, v12, vcc
L_q_wait:
    ds_read_b32 v16, v15 offset:16
    s_waitcnt lgkmcnt(0)
    v_readfirstlane_b32 s44, v16
    s_nop 0
    s_cmp_ge_u32 s44, 1
    s_cbranch_scc1 L_q_wait_ok
    s_sleep 1
    s_branch L_q_wait
L_q_wait_ok:
    ds_read_b128 v[64:67], v8 offset:0
    ds_read_b128 v[68:71], v8 offset:64
    ds_read_b128 v[72:75], v8 offset:128
    ds_read_b128 v[76:79], v8 offset:192
    ds_read_b128 v[80:83], v9 offset:0
    ds_read_b128 v[84:87], v9 offset:64
    ds_read_b128 v[88:91], v9 offset:128
    ds_read_b128 v[92:95], v9 offset:192
    s_waitcnt lgkmcnt(4)
    ds_read_b128 v[96:99], v10 offset:0
    ds_read_b128 v[100:103], v10 offset:64
    ds_read_b128 v[104:107], v10 offset:128
    ds_read_b128 v[108:111], v10 offset:192
    s_waitcnt lgkmcnt(4)
    ds_read_b128 v[112:115], v11 offset:0
    ds_read_b128 v[116:119], v11 offset:64
    ds_read_b128 v[120:123], v11 offset:128
    ds_read_b128 v[124:127], v11 offset:192
    s_waitcnt lgkmcnt(0)
    s_waitcnt vmcnt(12)
    ds_read_b128 v[32:35], v4 offset:0
    ds_read_b128 v[36:39], v5 offset:0
    ds_read_b128 v[40:43], v6 offset:0
    ds_read_b128 v[44:47], v7 offset:0
    s_waitcnt vmcnt(8)
    ds_read_b128 v[48:51], v4 offset:4096
    ds_read_b128 v[52:55], v5 offset:4096
    ds_read_b128 v[56:59], v6 offset:4096
    ds_read_b128 v[60:63], v7 offset:4096
    s_waitcnt lgkmcnt(4)
    v_mfma_f32_16x16x32_bf16 v[20:23], v[64:67], v[32:35], 0
    v_mfma_f32_16x16x32_bf16 v[20:23], v[68:71], v[36:39], v[20:23]
    v_mfma_f32_16x16x32_bf16 v[20:23], v[72:75], v[40:43], v[20:23]
    v_mfma_f32_16x16x32_bf16 v[20:23], v[76:79], v[44:47], v[20:23]
    s_nop 7
    s_waitcnt vmcnt(4)
    ds_read_b128 v[32:35], v4 offset:8192
    ds_read_b128 v[36:39], v5 offset:8192
    ds_read_b128 v[40:43], v6 offset:8192
    ds_read_b128 v[44:47], v7 offset:8192
    s_waitcnt lgkmcnt(4)
    v_mfma_f32_16x16x32_bf16 v[20:23], v[80:83], v[48:51], v[20:23]
    v_mfma_f32_16x16x32_bf16 v[20:23], v[84:87], v[52:55], v[20:23]
    v_mfma_f32_16x16x32_bf16 v[20:23], v[88:91], v[56:59], v[20:23]
    v_mfma_f32_16x16x32_bf16 v[20:23], v[92:95], v[60:63], v[20:23]
    s_nop 7
    s_waitcnt vmcnt(0)
    ds_read_b128 v[48:51], v4 offset:12288
    ds_read_b128 v[52:55], v5 offset:12288
    ds_read_b128 v[56:59], v6 offset:12288
    ds_read_b128 v[60:63], v7 offset:12288
    s_waitcnt lgkmcnt(4)
    v_mfma_f32_16x16x32_bf16 v[20:23], v[96:99], v[32:35], v[20:23]
    v_mfma_f32_16x16x32_bf16 v[20:23], v[100:103], v[36:39], v[20:23]
    v_mfma_f32_16x16x32_bf16 v[20:23], v[104:107], v[40:43], v[20:23]
    v_mfma_f32_16x16x32_bf16 v[20:23], v[108:111], v[44:47], v[20:23]
    s_waitcnt lgkmcnt(0)
    v_mfma_f32_16x16x32_bf16 v[20:23], v[112:115], v[48:51], v[20:23]
    v_mfma_f32_16x16x32_bf16 v[20:23], v[116:119], v[52:55], v[20:23]
    v_mfma_f32_16x16x32_bf16 v[20:23], v[120:123], v[56:59], v[20:23]
    v_mfma_f32_16x16x32_bf16 v[20:23], v[124:127], v[60:63], v[20:23]
    s_movk_i32 s45, 1023
    s_add_u32 s60, s7, 1
    s_xor_b32 s58, s58, s60
    s_and_b32 s58, s58, s45
    s_cselect_b32 s58, 0, 1
    s_add_u32 s60, s60, s58
    s_and_b32 s7, s60, s45
    v_mov_b32 v19, s7
    s_mov_b32 s48, 1035273459
    s_mov_b32 s49, 1069066811
    s_mov_b32 s50, 0xffff0000
    v_cvt_pk_bf16_f32 v24, v20, v21
    v_lshlrev_b32 v20, 16, v24
    v_and_b32 v21, s50, v24
    v_mul_f32 v20, s48, v20
    v_mul_f32 v21, s48, v21
    v_cvt_pk_bf16_f32 v24, v20, v21
    v_lshlrev_b32 v20, 16, v24
    v_and_b32 v21, s50, v24
    s_nop 0
    v_max_f32_dpp v24, v20, v20 quad_perm:[1,0,3,2] row_mask:0xf bank_mask:0xf
    v_max_f32_dpp v26, v21, v21 quad_perm:[1,0,3,2] row_mask:0xf bank_mask:0xf
    s_nop 0
    v_max_f32_dpp v24, v24, v24 quad_perm:[2,3,0,1] row_mask:0xf bank_mask:0xf
    v_max_f32_dpp v26, v26, v26 quad_perm:[2,3,0,1] row_mask:0xf bank_mask:0xf
    s_nop 0
    v_max_f32_dpp v24, v24, v24 row_half_mirror row_mask:0xf bank_mask:0xf
    v_max_f32_dpp v26, v26, v26 row_half_mirror row_mask:0xf bank_mask:0xf
    s_nop 0
    v_max_f32_dpp v24, v24, v24 row_mirror row_mask:0xf bank_mask:0xf
    v_max_f32_dpp v26, v26, v26 row_mirror row_mask:0xf bank_mask:0xf
    s_nop 0
    v_max_f32_dpp v24, v24, v24 row_bcast:15 row_mask:0xa bank_mask:0xf
    v_max_f32_dpp v26, v26, v26 row_bcast:15 row_mask:0xa bank_mask:0xf
    s_nop 0
    v_max_f32_dpp v24, v24, v24 row_bcast:31 row_mask:0xc bank_mask:0xf
    v_max_f32_dpp v26, v26, v26 row_bcast:31 row_mask:0xc bank_mask:0xf
    v_readlane_b32 s54, v24, 63
    v_readlane_b32 s55, v26, 63
    s_nop 0
    v_subrev_f32 v20, s54, v20
    v_subrev_f32 v21, s55, v21
    v_mul_f32 v20, s49, v20
    v_mul_f32 v21, s49, v21
    v_exp_f32 v20, v20
    v_exp_f32 v21, v21
    v_and_b32 v28, 3, v0
    v_lshlrev_b32 v28, 6, v28
    v_and_b32 v29, 0x3c, v0
    v_add_u32 v28, v28, v29
    s_lshl_b32 s44, s3, 8
    s_add_u32 s44, s44, 131072
    v_add_u32 v28, s44, v28
    v_cvt_pk_bf16_f32 v22, v20, v20
    v_cvt_pk_bf16_f32 v23, v21, v21
    ds_write_b32 v28, v22 offset:3840
    ds_write_b32 v28, v23 offset:5888
    v_add_f32_dpp v25, v20, v20 quad_perm:[1,0,3,2] row_mask:0xf bank_mask:0xf
    v_add_f32_dpp v27, v21, v21 quad_perm:[1,0,3,2] row_mask:0xf bank_mask:0xf
    s_nop 0
    v_add_f32_dpp v25, v25, v25 quad_perm:[2,3,0,1] row_mask:0xf bank_mask:0xf
    v_add_f32_dpp v27, v27, v27 quad_perm:[2,3,0,1] row_mask:0xf bank_mask:0xf
    s_nop 0
    v_add_f32_dpp v25, v25, v25 row_half_mirror row_mask:0xf bank_mask:0xf
    v_add_f32_dpp v27, v27, v27 row_half_mirror row_mask:0xf bank_mask:0xf
    s_nop 0
    v_add_f32_dpp v25, v25, v25 row_mirror row_mask:0xf bank_mask:0xf
    v_add_f32_dpp v27, v27, v27 row_mirror row_mask:0xf bank_mask:0xf
    s_nop 0
    v_add_f32_dpp v25, v25, v25 row_bcast:15 row_mask:0xa bank_mask:0xf
    v_add_f32_dpp v27, v27, v27 row_bcast:15 row_mask:0xa bank_mask:0xf
    s_nop 0
    v_add_f32_dpp v25, v25, v25 row_bcast:31 row_mask:0xc bank_mask:0xf
    v_add_f32_dpp v27, v27, v27 row_bcast:31 row_mask:0xc bank_mask:0xf
    s_lshl_b32 s44, s3, 4
    s_add_u32 s44, s44, 131072
    v_mov_b32 v28, s44
    s_mov_b32 exec_lo, 0
    s_mov_b32 exec_hi, 0x80000000
    ds_write_b128 v28, v[24:27] offset:3328
    s_mov_b64 exec, 1
    ds_add_rtn_u32 v17, v15, v18 offset:0
    s_mov_b64 exec, -1
    s_waitcnt lgkmcnt(0)
    v_readfirstlane_b32 s44, v17
    s_nop 0
    s_cmp_lg_u32 s44, 7
    s_cbranch_scc1 L_A_role
    v_and_b32 v20, 7, v0
    v_lshlrev_b32 v20, 4, v20
    v_and_b32 v21, 8, v0
    v_add_u32 v20, v21, v20
    v_add_u32 v20, 131072, v20
    ds_read_b64 v[22:23], v20 offset:3328
    ds_read_b32 v28, v15 offset:32
    s_lshl_b32 s44, s4, 12
    s_lshl_b32 s47, s5, 8
    s_add_u32 s44, s44, s47
    s_add_u32 s44, s44, 266240
    v_lshlrev_b32 v21, 4, v0
    s_waitcnt lgkmcnt(0)
    v_max_f32_dpp v24, v22, v22 quad_perm:[1,0,3,2] row_mask:0xf bank_mask:0xf
    s_nop 1
    v_max_f32_dpp v24, v24, v24 quad_perm:[2,3,0,1] row_mask:0xf bank_mask:0xf
    s_nop 1
    v_max_f32_dpp v24, v24, v24 row_half_mirror row_mask:0xf bank_mask:0xf
    v_sub_f32 v22, v22, v24
    v_mul_f32 v22, s49, v22
    v_exp_f32 v22, v22
    s_nop 0
    v_mul_f32 v25, v22, v23
    s_nop 1
    v_add_f32_dpp v25, v25, v25 quad_perm:[1,0,3,2] row_mask:0xf bank_mask:0xf
    s_nop 1
    v_add_f32_dpp v25, v25, v25 quad_perm:[2,3,0,1] row_mask:0xf bank_mask:0xf
    s_nop 1
    v_add_f32_dpp v25, v25, v25 row_half_mirror row_mask:0xf bank_mask:0xf
    v_bfi_b32 v24, s45, v19, v24
    v_bfi_b32 v25, s45, v19, v25
    v_mov_b32 v26, v24
    v_mov_b32 v27, v25
    v_readfirstlane_b32 s47, v28
    s_mov_b64 exec, 0xffff
    s_cmp_lg_u32 s47, 0
    s_cbranch_scc1 L_mlfar
    buffer_store_dwordx4 v[24:27], v21, s[36:39], s44 offen
    s_branch L_mldone
L_mlfar:
    buffer_store_dwordx4 v[24:27], v21, s[36:39], s44 offen sc1
L_mldone:
    s_mov_b64 exec, -1
L_A_role:
    s_cmp_lt_u32 s5, 9
    s_cbranch_scc1 L_A_mlp
    s_cmp_eq_u32 s5, 15
    s_cbranch_scc1 L_exit
    s_cmp_ge_u32 s5, 12
    s_cselect_b32 s53, 1, 0
    s_mul_i32 s44, s53, 3
    s_sub_u32 s54, s5, 9
    s_sub_u32 s54, s54, s44
    s_lshl_b32 s55, s4, 1
    s_add_u32 s55, s55, s53
    s_lshl_b32 s44, s55, 3
    s_add_u32 s44, s44, s3
    s_mul_i32 s44, s44, 18432
    s_mul_i32 s47, s54, 384
    s_add_u32 s44, s44, s47
    s_add_u32 s32, s16, s44
    s_addc_u32 s33, s17, 0
    s_mov_b32 s34, 17664
    s_mov_b32 s35, 0x20000
    v_add_u32 v8, 0, v0
    v_mul_u32_u24 v9, 2731, v8
    v_lshrrev_b32 v9, 16, v9
    v_and_b32 v10, 2, v9
    v_lshlrev_b32 v10, 4, v10
    v_mul_u32_u24 v9, 768, v9
    v_lshl_add_u32 v4, v8, 4, v9
    v_xor_b32 v4, v4, v10
    v_xor_b32 v49, 64, v4
    v_add_u32 v8, 64, v0
    v_mul_u32_u24 v9, 2731, v8
    v_lshrrev_b32 v9, 16, v9
    v_and_b32 v10, 2, v9
    v_lshlrev_b32 v10, 4, v10
    v_mul_u32_u24 v9, 768, v9
    v_lshl_add_u32 v5, v8, 4, v9
    v_xor_b32 v5, v5, v10
    v_xor_b32 v50, 64, v5
    v_add_u32 v8, 128, v0
    v_mul_u32_u24 v9, 2731, v8
    v_lshrrev_b32 v9, 16, v9
    v_and_b32 v10, 2, v9
    v_lshlrev_b32 v10, 4, v10
    v_mul_u32_u24 v9, 768, v9
    v_lshl_add_u32 v6, v8, 4, v9
    v_xor_b32 v6, v6, v10
    v_xor_b32 v51, 64, v6
    v_bfe_u32 v10, v0, 2, 2
    v_lshl_add_u32 v10, v3, 3, v10
    v_mul_u32_u24 v10, 384, v10
    v_and_b32 v11, 3, v0
    v_lshl_add_u32 v10, v11, 3, v10
    s_lshl_b32 s44, s3, 6
    v_add_u32 v10, s44, v10
    v_and_b32 v11, 24, v0
    v_lshlrev_b32 v11, 2, v11
    v_xor_b32 v10, v10, v11
    v_xor_b32 v52, 32, v10
    v_lshlrev_b32 v11, 2, v0
    s_lshl_b32 s57, s4, 12
    s_lshl_b32 s47, s53, 7
    s_add_u32 s57, s57, s47
    s_add_u32 s57, s57, 266240
    v_lshlrev_b32 v8, 8, v2
    s_lshl_b32 s58, s4, 4
    s_add_u32 s58, s58, s3
    s_lshl_b32 s58, s58, 10
    s_lshl_b32 s47, s53, 9
    s_add_u32 s58, s58, s47
    s_add_u32 s58, s58, 4096
    v_lshrrev_b32 v12, 5, v0
    v_and_b32 v13, 31, v0
    v_lshlrev_b32 v7, 13, v12
    v_lshl_add_u32 v7, v13, 4, v7
    v_mul_u32_u24 v12, 2176, v12
    v_lshl_add_u32 v12, v2, 4, v12
    v_and_b32 v13, 1, v3
    v_lshl_add_u32 v12, v13, 3, v12
    s_mul_i32 s44, s3, 272
    s_add_u32 s44, s44, 49152
    v_add_u32 v12, s44, v12
    v_mul_u32_u24 v9, 272, v2
    v_lshl_add_u32 v9, v3, 4, v9
    v_add_u32 v9, 49152, v9
    s_add_u32 s59, s55, 64
    s_mul_i32 s59, s59, 4736
    s_mul_i32 s47, s54, 1536
    s_add_u32 s59, s59, s47
    s_lshl_b32 s44, s3, 8
    s_add_u32 s59, s59, s44
    s_add_u32 s59, s59, 331776
    s_mul_i32 s44, s3, 6144
    s_mov_b32 m0, s44
    s_movk_i32 s47, 9216
    s_add_u32 s52, s3, 8
L_wo_pwait:
    ds_read_b32 v16, v15 offset:0
    s_waitcnt lgkmcnt(0)
    v_readfirstlane_b32 s44, v16
    s_nop 0
    s_cmp_ge_u32 s44, 8
    s_cbranch_scc1 L_wo_pwait_ok
    s_sleep 2
    s_branch L_wo_pwait
L_wo_pwait_ok:
    s_lshl_b32 s44, s3, 2
    v_add_u32 v53, s44, v15
L_wo_vwait:
    ds_read_b32 v16, v15 offset:40
    s_waitcnt lgkmcnt(0)
    v_readfirstlane_b32 s44, v16
    s_nop 0
    s_cmp_ge_u32 s44, 8
    s_cbranch_scc1 L_wo_vwait_ok
    s_sleep 1
    s_branch L_wo_vwait
L_wo_vwait_ok:
    buffer_load_dwordx4 v[20:23], v8, s[36:39], s57 offen sc1
    buffer_load_dwordx4 v4, s[32:35], 0 offen nt lds
    s_add_u32 m0, m0, 0x400
    s_nop 0
    buffer_load_dwordx4 v5, s[32:35], 0 offen nt lds
    s_add_u32 m0, m0, 0x400
    s_nop 0
    buffer_load_dwordx4 v6, s[32:35], 0 offen nt lds
    s_add_u32 m0, m0, 0x400
    s_nop 0
    buffer_load_dwordx4 v49, s[32:35], s47 offen nt lds
    s_add_u32 m0, m0, 0x400
    s_waitcnt vmcnt(3)
    buffer_load_dwordx4 v50, s[32:35], s47 offen nt lds
    s_add_u32 m0, m0, 0x400
    s_waitcnt vmcnt(3)
    buffer_load_dwordx4 v51, s[32:35], s47 offen nt lds
    s_waitcnt vmcnt(6)
    s_branch L_mlchk
L_mlpoll:
    buffer_load_dwordx4 v[20:23], v8, s[36:39], s57 offen sc1
    s_waitcnt vmcnt(0)
L_mlchk:
    v_xor_b32 v20, s7, v20
    v_xor_b32 v21, s7, v21
    v_xor_b32 v22, s7, v22
    v_xor_b32 v23, s7, v23
    v_or3_b32 v24, v20, v21, v22
    v_or_b32 v24, v24, v23
    v_and_b32 v24, s45, v24
    v_cmp_ne_u32 vcc, 0, v24
    s_cbranch_vccz L_mlok
    s_sleep 4
    s_add_u32 s46, s46, 1
    s_and_b32 s44, s46, 255
    s_cbranch_scc1 L_mlpoll
    buffer_wbl2 sc1
    buffer_inv sc1
    s_waitcnt vmcnt(0)
    s_cmp_le_u32 s46, 200000
    s_cbranch_scc1 L_mlpoll
L_mlok:
    v_max_f32_dpp v24, v20, v20 quad_perm:[1,0,3,2] row_mask:0xf bank_mask:0xf
    s_nop 1
    v_max_f32_dpp v24, v24, v24 quad_perm:[2,3,0,1] row_mask:0xf bank_mask:0xf
    s_nop 1
    v_max_f32_dpp v24, v24, v24 row_half_mirror row_mask:0xf bank_mask:0xf
    v_sub_f32 v20, v20, v24
    v_mul_f32 v20, s49, v20
    v_exp_f32 v20, v20
    s_nop 0
    v_mul_f32 v25, v20, v21
    s_nop 1
    v_add_f32_dpp v25, v25, v25 quad_perm:[1,0,3,2] row_mask:0xf bank_mask:0xf
    s_nop 1
    v_add_f32_dpp v25, v25, v25 quad_perm:[2,3,0,1] row_mask:0xf bank_mask:0xf
    s_nop 1
    v_add_f32_dpp v25, v25, v25 row_half_mirror row_mask:0xf bank_mask:0xf
    v_rcp_f32 v25, v25
    s_nop 0
    v_mul_f32 v14, v20, v25
    s_nop 0
    v_readlane_b32 s54, v14, s3
    v_readlane_b32 s55, v14, s52
    s_nop 1
    v_mov_b32 v14, s55
    s_mov_b32 exec_hi, 0
    v_mov_b32 v14, s54
    s_mov_b32 exec_hi, -1
    s_waitcnt vmcnt(0)
    buffer_load_dwordx4 v[20:23], v7, s[36:39], s58 offen sc1
    s_barrier
    s_cmp_ge_u32 s3, 6
    s_cbranch_scc1 L_ochk
    ds_read_b64_tr_b16 v[64:65], v10 offset:0
    ds_read_b64_tr_b16 v[66:67], v10 offset:1536
    ds_read_b64_tr_b16 v[68:69], v10 offset:12288
    ds_read_b64_tr_b16 v[70:71], v10 offset:13824
    ds_read_b64_tr_b16 v[72:73], v10 offset:24576
    ds_read_b64_tr_b16 v[74:75], v10 offset:26112
    ds_read_b64_tr_b16 v[76:77], v10 offset:36864
    ds_read_b64_tr_b16 v[78:79], v10 offset:38400
    s_waitcnt lgkmcnt(4)
    ds_read_b64_tr_b16 v[80:81], v52 offset:0
    ds_read_b64_tr_b16 v[82:83], v52 offset:1536
    ds_read_b64_tr_b16 v[84:85], v52 offset:12288
    ds_read_b64_tr_b16 v[86:87], v52 offset:13824
    ds_read_b64_tr_b16 v[88:89], v52 offset:24576
    ds_read_b64_tr_b16 v[90:91], v52 offset:26112
    ds_read_b64_tr_b16 v[92:93], v52 offset:36864
    ds_read_b64_tr_b16 v[94:95], v52 offset:38400
    s_branch L_ochk
L_opoll:
    buffer_load_dwordx4 v[20:23], v7, s[36:39], s58 offen sc1
L_ochk:
    s_waitcnt vmcnt(0)
    v_xor_b32 v20, s7, v20
    v_xor_b32 v21, s7, v21
    v_xor_b32 v22, s7, v22
    v_xor_b32 v23, s7, v23
    v_or3_b32 v24, v20, v21, v22
    v_or_b32 v24, v24, v23
    v_and_b32 v24, s45, v24
    v_cmp_ne_u32 vcc, 0, v24
    s_cbranch_vccz L_ook
    s_sleep 1
    s_add_u32 s46, s46, 1
    s_and_b32 s44, s46, 255
    s_cbranch_scc1 L_opoll
    buffer_wbl2 sc1
    buffer_inv sc1
    s_waitcnt vmcnt(0)
    s_cmp_le_u32 s46, 200000
    s_cbranch_scc1 L_opoll
L_ook:
    v_pk_mul_f32 v[20:21], v[20:21], v[14:15] op_sel_hi:[1,0]
    v_pk_mul_f32 v[22:23], v[22:23], v[14:15] op_sel_hi:[1,0]
    v_cvt_pk_bf16_f32 v20, v20, v21
    v_cvt_pk_bf16_f32 v21, v22, v23
    ds_write_b64 v12, v[20:21]
    s_waitcnt lgkmcnt(0)
    s_barrier
    s_cmp_ge_u32 s3, 6
    s_cbranch_scc1 L_exit
    ds_read_b128 v[32:35], v9 offset:0
    ds_read_b128 v[36:39], v9 offset:64
    ds_read_b128 v[40:43], v9 offset:128
    ds_read_b128 v[44:47], v9 offset:192
    s_waitcnt lgkmcnt(3)
    v_mfma_f32_16x16x32_bf16 v[24:27], v[64:67], v[32:35], 0
    v_mfma_f32_16x16x32_bf16 v[28:31], v[80:83], v[32:35], 0
    s_waitcnt lgkmcnt(2)
    v_mfma_f32_16x16x32_bf16 v[24:27], v[68:71], v[36:39], v[24:27]
    v_mfma_f32_16x16x32_bf16 v[28:31], v[84:87], v[36:39], v[28:31]
    s_waitcnt lgkmcnt(1)
    v_mfma_f32_16x16x32_bf16 v[24:27], v[72:75], v[40:43], v[24:27]
    v_mfma_f32_16x16x32_bf16 v[28:31], v[88:91], v[40:43], v[28:31]
    s_waitcnt lgkmcnt(0)
    v_mfma_f32_16x16x32_bf16 v[24:27], v[76:79], v[44:47], v[24:27]
    v_mfma_f32_16x16x32_bf16 v[28:31], v[92:95], v[44:47], v[28:31]
    s_nop 6
    v_add_f32_dpp v24, v24, v24 row_half_mirror row_mask:0xf bank_mask:0x5
    v_add_f32_dpp v25, v25, v25 row_half_mirror row_mask:0xf bank_mask:0x5
    v_add_f32_dpp v26, v26, v26 row_half_mirror row_mask:0xf bank_mask:0x5
    v_add_f32_dpp v27, v27, v27 row_half_mirror row_mask:0xf bank_mask:0x5
    v_add_f32_dpp v24, v28, v28 row_half_mirror row_mask:0xf bank_mask:0xa
    v_add_f32_dpp v25, v29, v29 row_half_mirror row_mask:0xf bank_mask:0xa
    v_add_f32_dpp v26, v30, v30 row_half_mirror row_mask:0xf bank_mask:0xa
    v_add_f32_dpp v27, v31, v31 row_half_mirror row_mask:0xf bank_mask:0xa
    v_add_f32_dpp v24, v24, v24 quad_perm:[1,0,3,2] row_mask:0xf bank_mask:0xf
    v_add_f32_dpp v25, v25, v25 quad_perm:[1,0,3,2] row_mask:0xf bank_mask:0xf
    v_add_f32_dpp v26, v26, v26 quad_perm:[1,0,3,2] row_mask:0xf bank_mask:0xf
    v_add_f32_dpp v27, v27, v27 quad_perm:[1,0,3,2] row_mask:0xf bank_mask:0xf
    v_add_f32_dpp v24, v24, v24 quad_perm:[2,3,0,1] row_mask:0xf bank_mask:0xf
    v_add_f32_dpp v25, v25, v25 quad_perm:[2,3,0,1] row_mask:0xf bank_mask:0xf
    v_add_f32_dpp v26, v26, v26 quad_perm:[2,3,0,1] row_mask:0xf bank_mask:0xf
    v_add_f32_dpp v27, v27, v27 quad_perm:[2,3,0,1] row_mask:0xf bank_mask:0xf
    s_mov_b32 vcc_lo, 0xaaaaaaaa
    s_mov_b32 vcc_hi, 0xaaaaaaaa
    v_cndmask_b32 v24, v24, v25, vcc
    v_cndmask_b32 v26, v26, v27, vcc
    s_mov_b32 vcc_lo, 0xcccccccc
    s_mov_b32 vcc_hi, 0xcccccccc
    v_cndmask_b32 v24, v24, v26, vcc
    v_bfi_b32 v24, s45, v19, v24
    buffer_store_dword v24, v11, s[36:39], s59 offen sc1
    s_endpgm
L_A_mlp:
    s_cmp_eq_u32 s3, 7
    s_cbranch_scc1 L_A_fin
    s_cmp_eq_u32 s3, 6
    s_cbranch_scc1 L_exit
    s_cmp_ge_u32 s52, 3
    s_cselect_b32 s54, 1, 0
    s_mul_i32 s55, s54, 3
    s_add_u32 s56, s55, s3
    s_sub_u32 s55, s52, s55
    s_cmp_ge_u32 s3, 3
    s_cbranch_scc1 L_A_wd
    s_cmp_ge_u32 s56, 4
    s_cselect_b32 s44, 7, 8
    s_cselect_b32 s47, 1024, 0
    v_bfe_u32 v13, v0, 2, 2
    v_lshlrev_b32 v13, s44, v13
    v_and_b32 v9, 1, v3
    v_mul_u32_u24 v9, 4992, v9
    v_add_u32 v13, v13, v9
    v_and_b32 v9, 3, v0
    v_lshl_add_u32 v13, v9, 4, v13
    s_and_b32 s44, s56, 3
    s_lshl_b32 s44, s44, 6
    s_add_u32 s44, s44, s47
    v_add_u32 v13, s44, v13
    v_add_u32 v12, 3328, v13
    s_mov_b32 exec_lo, 0
    v_add_u32 v13, 1664, v13
    v_and_b32 v12, 31, v0
    v_min_u32 v12, 5, v12
    v_mul_u32_u24 v12, 1664, v12
    v_add_u32 v12, 1536, v12
    s_mov_b32 exec_lo, -1
    s_mul_i32 s57, s51, 9984
    s_add_u32 s57, s57, 851968
    v_bfe_u32 v10, v0, 2, 1
    v_lshl_add_u32 v10, v10, 2, v3
    v_lshl_add_u32 v10, v9, 3, v10
    s_lshl_b32 s44, s3, 5
    v_add_u32 v10, s44, v10
    v_bfe_u32 v11, v0, 3, 1
    v_mul_u32_u24 v11, 192, v11
    v_lshl_add_u32 v11, v10, 1, v11
    v_add_u32 v11, v15, v11
    v_lshl_add_u32 v10, v10, 2, v15
L_hpoll:
    buffer_load_dwordx4 v[32:35], v13, s[36:39], s57 offen sc1
    buffer_load_dwordx4 v[36:39], v12, s[36:39], s57 offen sc1
    s_waitcnt vmcnt(0)
    v_xor_b32 v32, s7, v32
    v_xor_b32 v33, s7, v33
    v_xor_b32 v34, s7, v34
    v_xor_b32 v35, s7, v35
    v_xor_b32 v36, s7, v36
    v_xor_b32 v37, s7, v37
    v_xor_b32 v38, s7, v38
    v_xor_b32 v39, s7, v39
    v_or3_b32 v48, v32, v33, v34
    v_or3_b32 v48, v48, v35, v36
    v_or3_b32 v48, v48, v37, v38
    v_or_b32 v48, v48, v39
    v_and_b32 v48, s45, v48
    v_cmp_ne_u32 vcc, 0, v48
    s_cbranch_vccz L_hok
    s_sleep 8
    s_add_u32 s46, s46, 1
    s_and_b32 s44, s46, 255
    s_cbranch_scc1 L_hpoll
    buffer_wbl2 sc1
    buffer_inv sc1
    s_waitcnt vmcnt(0)
    s_cmp_le_u32 s46, 200000
    s_cbranch_scc1 L_hpoll
L_hok:
    s_getreg_b32 s44, hwreg(HW_REG_XCC_ID, 0, 4)
    s_lshl_b32 s44, s44, 16
    s_mov_b32 exec_lo, 0
    v_cmp_ne_u32 vcc, s44, v36
    s_mov_b32 exec_lo, -1
    s_cbranch_vccz L_hnear
    buffer_wbl2 sc1
    s_waitcnt vmcnt(0)
L_hnear:
    s_mov_b32 exec_hi, 0
    v_pk_add_f32 v[32:33], v[32:33], v[36:37]
    v_pk_add_f32 v[34:35], v[34:35], v[38:39]
    s_mov_b32 exec_hi, -1
    s_nop 0
    v_permlane32_swap_b32 v32, v34
    v_permlane32_swap_b32 v33, v35
    v_add_f32 v32, v32, v34
    v_add_f32 v33, v33, v35
    s_nop 1
    v_permlane16_swap_b32 v32, v33
    v_cvt_pk_bf16_f32 v24, v32, v33
    v_and_b32 v25, s50, v24
    v_lshlrev_b32 v24, 16, v24
    v_cmp_lt_f32 vcc, 0, v24
    s_nop 1
    v_cndmask_b32 v26, 0, 1.0, vcc
    v_mul_f32 v24, v24, v26
    v_mul_f32 v24, v24, v25
    v_cvt_pk_bf16_f32 v24, v24, v24
    ds_write_b16 v11, v24 offset:3456
    s_nop 0
    v_or_b32_dpp v25, v24, v24 row_ror:8 row_mask:0xf bank_mask:0xf
    v_lshlrev_b32 v25, 17, v25
    ds_write_b32 v10, v25 offset:1024
    s_mov_b64 exec, 1
    ds_add_u32 v15, v18 offset:20
    s_mov_b64 exec, -1
L_A_wd:
    s_lshl_b32 s56, s51, 1
    s_add_u32 s56, s56, s54
    s_mul_i32 s44, s56, 6
    s_add_u32 s44, s44, s3
    s_mul_i32 s44, s44, 18432
    s_mul_i32 s47, s55, 384
    s_add_u32 s44, s44, s47
    s_add_u32 s32, s24, s44
    s_addc_u32 s33, s25, 0
    s_mov_b32 s34, 17664
    s_mov_b32 s35, 0x20000
    s_lshl_b32 s44, s3, 6
    v_add_u32 v57, s44, v15
    v_add_u32 v8, 0, v0
    v_mul_u32_u24 v9, 2731, v8
    v_lshrrev_b32 v9, 16, v9
    v_lshl_add_u32 v54, v9, 2, v57
    v_and_b32 v10, 2, v9
    v_lshlrev_b32 v10, 4, v10
    v_mul_u32_u24 v9, 768, v9
    v_lshl_add_u32 v4, v8, 4, v9
    v_xor_b32 v4, v4, v10
    v_xor_b32 v49, 64, v4
    v_add_u32 v8, 64, v0
    v_mul_u32_u24 v9, 2731, v8
    v_lshrrev_b32 v9, 16, v9
    v_lshl_add_u32 v55, v9, 2, v57
    v_and_b32 v10, 2, v9
    v_lshlrev_b32 v10, 4, v10
    v_mul_u32_u24 v9, 768, v9
    v_lshl_add_u32 v5, v8, 4, v9
    v_xor_b32 v5, v5, v10
    v_xor_b32 v50, 64, v5
    v_add_u32 v8, 128, v0
    v_mul_u32_u24 v9, 2731, v8
    v_lshrrev_b32 v9, 16, v9
    v_lshl_add_u32 v56, v9, 2, v57
    v_and_b32 v10, 2, v9
    v_lshlrev_b32 v10, 4, v10
    v_mul_u32_u24 v9, 768, v9
    v_lshl_add_u32 v6, v8, 4, v9
    v_xor_b32 v6, v6, v10
    v_xor_b32 v51, 64, v6
    v_bfe_u32 v10, v0, 2, 2
    v_lshl_add_u32 v10, v3, 3, v10
    v_mul_u32_u24 v10, 384, v10
    v_and_b32 v11, 3, v0
    v_lshl_add_u32 v10, v11, 3, v10
    s_lshl_b32 s44, s3, 6
    v_add_u32 v10, s44, v10
    v_and_b32 v11, 24, v0
    v_lshlrev_b32 v11, 2, v11
    v_xor_b32 v10, v10, v11
    v_xor_b32 v52, 32, v10
    v_lshlrev_b32 v11, 2, v0
    s_mul_i32 s59, s56, 4736
    s_mul_i32 s47, s55, 1536
    s_add_u32 s59, s59, s47
    s_lshl_b32 s44, s3, 8
    s_add_u32 s59, s59, s44
    s_add_u32 s59, s59, 331776
    v_lshrrev_b32 v9, 3, v2
    v_mul_u32_u24 v9, 192, v9
    v_lshl_add_u32 v9, v3, 4, v9
    v_add_u32 v9, v15, v9
    s_mul_i32 s44, s3, 6144
    s_mov_b32 m0, s44
    s_movk_i32 s47, 9216
L_h_wait:
    ds_read_b32 v16, v15 offset:20
    s_waitcnt lgkmcnt(0)
    v_readfirstlane_b32 s44, v16
    s_nop 0
    s_cmp_ge_u32 s44, 3
    s_cbranch_scc1 L_h_wait_ok
    s_sleep 4
    s_branch L_h_wait
L_h_wait_ok:
    ds_read_b128 v[32:35], v9 offset:3456
    ds_read_b128 v[36:39], v9 offset:3520
    ds_read_b128 v[40:43], v9 offset:3584
    ds_read_b32 v58, v54 offset:1024
    ds_read_b32 v61, v54 offset:1056
    ds_read_b32 v59, v55 offset:1024
    ds_read_b32 v62, v55 offset:1056
    ds_read_b32 v60, v56 offset:1024
    ds_read_b32 v63, v56 offset:1056
    v_bfrev_b32 v8, 1
    s_waitcnt lgkmcnt(0)
    v_cmp_ne_u32 vcc, 0, v58
    s_nop 1
    v_cndmask_b32 v4, v8, v4, vcc
    v_cmp_ne_u32 vcc, 0, v59
    s_nop 1
    v_cndmask_b32 v5, v8, v5, vcc
    v_cmp_ne_u32 vcc, 0, v60
    s_nop 1
    v_cndmask_b32 v6, v8, v6, vcc
    v_cmp_ne_u32 vcc, 0, v61
    s_nop 1
    v_cndmask_b32 v49, v8, v49, vcc
    v_cmp_ne_u32 vcc, 0, v62
    s_nop 1
    v_cndmask_b32 v50, v8, v50, vcc
    v_cmp_ne_u32 vcc, 0, v63
    s_nop 1
    v_cndmask_b32 v51, v8, v51, vcc
L_wd_pwait:
    ds_read_b32 v16, v15 offset:0
    s_waitcnt lgkmcnt(0)
    v_readfirstlane_b32 s44, v16
    s_nop 0
    s_cmp_ge_u32 s44, 8
    s_cbranch_scc1 L_wd_pwait_ok
    s_sleep 2
    s_branch L_wd_pwait
L_wd_pwait_ok:
L_v_wait:
    ds_read_b32 v16, v15 offset:40
    s_waitcnt lgkmcnt(0)
    v_readfirstlane_b32 s44, v16
    s_nop 0
    s_cmp_ge_u32 s44, 8
    s_cbranch_scc1 L_v_wait_ok
    s_sleep 1
    s_branch L_v_wait
L_v_wait_ok:
    buffer_load_dwordx4 v4, s[32:35], 0 offen nt lds
    s_add_u32 m0, m0, 0x400
    s_nop 0
    buffer_load_dwordx4 v5, s[32:35], 0 offen nt lds
    s_add_u32 m0, m0, 0x400
    s_nop 0
    buffer_load_dwordx4 v6, s[32:35], 0 offen nt lds
    s_add_u32 m0, m0, 0x400
    s_nop 0
    buffer_load_dwordx4 v49, s[32:35], s47 offen nt lds
    s_add_u32 m0, m0, 0x400
    s_nop 0
    buffer_load_dwordx4 v50, s[32:35], s47 offen nt lds
    s_add_u32 m0, m0, 0x400
    s_nop 0
    buffer_load_dwordx4 v51, s[32:35], s47 offen nt lds
    s_barrier
    s_waitcnt vmcnt(0)
    s_barrier
    ds_read_b64_tr_b16 v[64:65], v10 offset:0
    ds_read_b64_tr_b16 v[66:67], v10 offset:1536
    ds_read_b64_tr_b16 v[80:81], v52 offset:0
    ds_read_b64_tr_b16 v[82:83], v52 offset:1536
    ds_read_b64_tr_b16 v[68:69], v10 offset:12288
    ds_read_b64_tr_b16 v[70:71], v10 offset:13824
    ds_read_b64_tr_b16 v[84:85], v52 offset:12288
    ds_read_b64_tr_b16 v[86:87], v52 offset:13824
    ds_read_b64_tr_b16 v[72:73], v10 offset:24576
    ds_read_b64_tr_b16 v[74:75], v10 offset:26112
    ds_read_b64_tr_b16 v[88:89], v52 offset:24576
    ds_read_b64_tr_b16 v[90:91], v52 offset:26112
    s_waitcnt lgkmcnt(10)
    v_mfma_f32_16x16x32_bf16 v[24:27], v[64:67], v[32:35], 0
    s_waitcnt lgkmcnt(8)
    v_mfma_f32_16x16x32_bf16 v[28:31], v[80:83], v[32:35], 0
    s_waitcnt lgkmcnt(6)
    v_mfma_f32_16x16x32_bf16 v[24:27], v[68:71], v[36:39], v[24:27]
    s_waitcnt lgkmcnt(4)
    v_mfma_f32_16x16x32_bf16 v[28:31], v[84:87], v[36:39], v[28:31]
    s_waitcnt lgkmcnt(2)
    v_mfma_f32_16x16x32_bf16 v[24:27], v[72:75], v[40:43], v[24:27]
    s_waitcnt lgkmcnt(0)
    v_mfma_f32_16x16x32_bf16 v[28:31], v[88:91], v[40:43], v[28:31]
    s_nop 7
    v_mov_b32_dpp v24, v28 quad_perm:[0,1,2,3] row_mask:0xf bank_mask:0xa
    v_mov_b32_dpp v25, v29 quad_perm:[0,1,2,3] row_mask:0xf bank_mask:0xa
    v_mov_b32_dpp v26, v30 quad_perm:[0,1,2,3] row_mask:0xf bank_mask:0xa
    v_mov_b32_dpp v27, v31 quad_perm:[0,1,2,3] row_mask:0xf bank_mask:0xa
    s_mov_b32 vcc_lo, 0xaaaaaaaa
    s_mov_b32 vcc_hi, 0xaaaaaaaa
    v_cndmask_b32 v24, v24, v25, vcc
    v_cndmask_b32 v26, v26, v27, vcc
    s_mov_b32 vcc_lo, 0xcccccccc
    s_mov_b32 vcc_hi, 0xcccccccc
    v_cndmask_b32 v24, v24, v26, vcc
    v_bfi_b32 v24, s45, v19, v24
    buffer_store_dword v24, v11, s[36:39], s59 offen sc1
    s_endpgm
L_A_fin:
    s_mov_b32 s40, s8
    s_mov_b32 s41, s9
    s_mov_b32 s42, 2304
    s_mov_b32 s43, 0x20000
    v_and_b32 v5, 1, v0
    v_and_b32 v4, 1, v3
    v_lshlrev_b32 v4, 2, v4
    v_lshl_add_u32 v4, v5, 5, v4
    s_and_b32 s44, s53, 1
    s_mul_i32 s44, s44, 1152
    s_lshr_b32 s47, s53, 3
    s_lshl_b32 s47, s47, 6
    s_add_u32 s44, s44, s47
    s_and_b32 s47, s53, 6
    s_lshl_b32 s47, s47, 2
    s_add_u32 s44, s44, s47
    v_add_u32 v4, s44, v4
    v_lshrrev_b32 v7, 5, v0
    v_lshl_add_u32 v4, v7, 1, v4
    buffer_load_ushort v10, v4, s[40:43], 0 offen
    s_mov_b32 s40, s26
    s_mov_b32 s41, s27
    s_mov_b32 s42, 2304
    s_mov_b32 s43, 0x20000
    v_lshrrev_b32 v6, 1, v0
    v_mul_u32_u24 v6, 4736, v6
    v_lshl_add_u32 v6, v5, 4, v6
    s_lshl_b32 s57, s53, 5
    s_add_u32 s57, s57, 331776
    s_add_u32 s58, s57, 151552
    s_add_u32 s59, s57, 303104
    v_mov_b32 v68, s7
    v_mov_b32 v69, s7
    v_mov_b32 v70, s7
    v_mov_b32 v71, s7
    s_mov_b32 s54, 0
    s_mov_b32 s55, 0
    s_barrier
    s_barrier
    s_waitcnt vmcnt(0)
    v_lshlrev_b32 v10, 16, v10
L_fpoll:
    s_cmp_lg_u32 s54, 0
    s_cbranch_scc1 L_f1
    buffer_load_dwordx4 v[64:67], v6, s[36:39], s57 offen sc1
    s_mov_b32 exec_hi, 0
    buffer_load_dwordx4 v[68:71], v6, s[36:39], s58 offen sc1
    s_mov_b32 exec_hi, -1
L_f1:
    s_cmp_lg_u32 s55, 0
    s_cbranch_scc1 L_f2
    buffer_load_dwordx4 v[72:75], v6, s[36:39], s59 offen sc1
    s_waitcnt vmcnt(0)
    v_xor_b32 v84, s7, v72
    v_xor_b32 v85, s7, v73
    v_xor_b32 v86, s7, v74
    v_xor_b32 v87, s7, v75
    v_or3_b32 v88, v84, v85, v86
    v_or_b32 v88, v88, v87
    v_and_b32 v88, s45, v88
    v_cmp_ne_u32 vcc, 0, v88
    s_cbranch_vccnz L_f2
    v_permlane16_swap_b32 v84, v86
    v_permlane16_swap_b32 v85, v87
    v_add_f32 v84, v84, v86
    v_add_f32 v85, v85, v87
    s_nop 1
    v_permlane32_swap_b32 v84, v85
    v_add_f32 v84, v84, v85
    s_nop 1
    v_add_f32_dpp v84, v84, v84 row_ror:8 row_mask:0xf bank_mask:0xf
    s_nop 1
    v_add_f32_dpp v84, v84, v84 row_ror:4 row_mask:0xf bank_mask:0xf
    s_nop 1
    v_add_f32_dpp v84, v84, v84 row_ror:2 row_mask:0xf bank_mask:0xf
    v_cvt_pk_bf16_f32 v84, v84, v84
    v_and_b32 v84, s50, v84
    s_mov_b32 s55, 1
    s_cmp_lg_u32 s54, 0
    s_cbranch_scc1 L_fok
L_f2:
    s_cmp_lg_u32 s54, 0
    s_cbranch_scc1 L_f3
    s_waitcnt vmcnt(0)
    v_xor_b32 v96, s7, v64
    v_xor_b32 v97, s7, v65
    v_xor_b32 v98, s7, v66
    v_xor_b32 v99, s7, v67
    v_xor_b32 v100, s7, v68
    v_xor_b32 v101, s7, v69
    v_xor_b32 v102, s7, v70
    v_xor_b32 v103, s7, v71
    v_or3_b32 v104, v96, v97, v98
    v_or3_b32 v104, v104, v99, v100
    v_or3_b32 v104, v104, v101, v102
    v_or_b32 v104, v104, v103
    v_and_b32 v104, s45, v104
    v_cmp_ne_u32 vcc, 0, v104
    s_cbranch_vccnz L_f3
    v_pk_add_f32 v[96:97], v[96:97], v[100:101]
    v_pk_add_f32 v[98:99], v[98:99], v[102:103]
    s_nop 1
    v_permlane16_swap_b32 v96, v98
    v_permlane16_swap_b32 v97, v99
    v_add_f32 v96, v96, v98
    v_add_f32 v97, v97, v99
    s_nop 1
    v_permlane32_swap_b32 v96, v97
    v_add_f32 v96, v96, v97
    s_nop 1
    v_add_f32_dpp v96, v96, v96 row_ror:8 row_mask:0xf bank_mask:0xf
    s_nop 1
    v_add_f32_dpp v96, v96, v96 row_ror:4 row_mask:0xf bank_mask:0xf
    s_nop 1
    v_add_f32_dpp v96, v96, v96 row_ror:2 row_mask:0xf bank_mask:0xf
    v_cvt_pk_bf16_f32 v96, v96, v96
    v_and_b32 v96, s50, v96
    v_mul_f32 v97, s49, v96
    v_exp_f32 v97, -v97
    s_nop 0
    v_add_f32 v97, 1.0, v97
    v_rcp_f32 v97, v97
    s_nop 0
    v_mul_f32 v96, v96, v97
    v_cvt_pk_bf16_f32 v96, v96, v96
    v_and_b32 v96, s50, v96
    s_mov_b32 s54, 1
    s_cmp_lg_u32 s55, 0
    s_cbranch_scc1 L_fok
L_f3:
    s_sleep 1
    s_add_u32 s46, s46, 1
    s_and_b32 s44, s46, 0xff
    s_cbranch_scc1 L_fpoll
    buffer_wbl2 sc1
    buffer_inv sc1
    s_waitcnt vmcnt(0)
    s_cmp_le_u32 s46, 200000
    s_cbranch_scc1 L_fpoll
L_fok:
    v_mul_f32 v84, v84, v96
    v_cvt_pk_bf16_f32 v84, v84, v84
    v_and_b32 v84, s50, v84
    v_add_f32 v84, v84, v10
    v_cvt_pk_bf16_f32 v96, v84, v84
    s_mov_b32 exec_lo, 0x00030003
    s_mov_b32 exec_hi, 0x00030003
    buffer_store_short v96, v4, s[40:43], 0 offen
    s_cmp_lg_u32 s53, 0
    s_cbranch_scc1 L_exit
    s_mov_b64 exec, 3
    v_mul_u32_u24 v4, 1310720, v0
    v_mov_b32 v5, s60
    buffer_store_dword v5, v4, s[36:39], 0 offen
    s_endpgm
L_exit:
L_end:
    s_endpgm
.section .rodata,"a"
.p2align 6
.amdhsa_kernel recurrent_scan__sliding_block_cached__glu_gated_reglu__decode_kernel
  .amdhsa_next_free_vgpr 128
  .amdhsa_next_free_sgpr 96
  .amdhsa_accum_offset 128
  .amdhsa_group_segment_fixed_size 0
  .amdhsa_kernarg_size 96
  .amdhsa_user_sgpr_count 2
  .amdhsa_user_sgpr_kernarg_segment_ptr 1
  .amdhsa_system_sgpr_workgroup_id_x 1
  .amdhsa_float_denorm_mode_32 3
.end_amdhsa_kernel
```
